```python
import torch

def _softmax(x, axis=-1):
    return torch.softmax(x, dim=axis)
def _gelu(x):
    return torch.nn.functional.gelu(x, approximate="tanh")
def _silu(x):
    return torch.nn.functional.silu(x)
def _sigmoid(x):
    return torch.sigmoid(x)
def _layernorm(x, axis=-1, eps=1e-5):
    m = x.mean(dim=axis, keepdim=True)
    v = x.var(dim=axis, keepdim=True, unbiased=False)
    return (x - m) / torch.sqrt(v + eps)
def _scatter_add(tgt, idx, src, axis=0):
    return tgt.clone().index_add_(axis, idx, src)
def _segment_sum(src, seg, n):
    out = torch.zeros((n,) + src.shape[1:], dtype=src.dtype)
    return out.index_add_(0, seg, src)
def _pad(x, pw):
    flat = tuple(v for pair in reversed(pw) for v in pair)
    return torch.nn.functional.pad(x, flat)

kernel_name = 'parallel_sum__sliding_block_cached__dense_activation_mish__decode'

def setup_inputs():

    _w = (lambda a: (lambda t: t.to(torch.bfloat16) if t.is_floating_point() else t)(torch.as_tensor(a)))
    def _A_setup():
        B, Sq, D = 2, 1, 512
        Hq, Hkv, Sk, Dh = 32, 8, 8192, 128
        assert Hq % Hkv == 0, (Hq, Hkv)
        return {
            "x": _w((lambda *s: torch.randn(*s, dtype=torch.bfloat16) * 0.05)(B, Sq, D)),
            "k_cache": _w((lambda *s: torch.randn(*s, dtype=torch.bfloat16) * 1.6)(B, Hkv, Sk, Dh)),
            "v_cache": _w((lambda *s: torch.randn(*s, dtype=torch.bfloat16) * 0.4)(B, Hkv, Sk, Dh)),
            "wq": _w((lambda *s: torch.randn(*s, dtype=torch.bfloat16) * 1.6)(D, Hq * Dh) * (D ** -0.5)),
            "wo": _w((lambda *s: torch.randn(*s, dtype=torch.bfloat16) * 0.4)(Hq * Dh, D) * ((Hq * Dh) ** -0.5)),
        }
    _A_in = _A_setup()

    def _B_setup():
        B, S, D, F = 2, 1, 512, 1792
        return {
            "x": _w((lambda *s: torch.randn(*s, dtype=torch.bfloat16) * 0.05)(B, S, D)),
            "w1": _w((lambda *s: torch.randn(*s, dtype=torch.bfloat16) * 0.8)(D, F) * (D ** -0.5)),
            "b1": _w((lambda *s: torch.randn(*s, dtype=torch.bfloat16) * 0.2)(F)),
            "w2": _w((lambda *s: torch.randn(*s, dtype=torch.bfloat16) * 0.1)(F, D) * (F ** -0.5)),
        }
    _B_in = _B_setup()

    return {
        "A_x": _A_in["x"],
        "A_k_cache": _A_in["k_cache"],
        "A_v_cache": _A_in["v_cache"],
        "A_wq": _A_in["wq"],
        "A_wo": _A_in["wo"],
        "B_x": _B_in["x"],
        "B_w1": _B_in["w1"],
        "B_b1": _B_in["b1"],
        "B_w2": _B_in["w2"],
    }

def reference(A_x, A_k_cache, A_v_cache, A_wq, A_wo, B_x, B_w1, B_b1, B_w2):
    def _A_ref(x, k_cache, v_cache, wq, wo):
        B, Sq, D = x.shape
        Hq, Dh = 32, 128
        Hkv, Sk = k_cache.shape[1], k_cache.shape[2]
        W = min(4096, max(256, Sk // 4))
        rep = Hq // Hkv
        q = (lambda x, *d: x.permute(*d))((x @ wq).reshape(B, Sq, Hq, Dh), 0, 2, 1, 3)
        k = (lambda x, n, axis: torch.repeat_interleave(x, n, dim=axis))(k_cache[:, :, Sk - W:, :], rep, axis=1)
        v = (lambda x, n, axis: torch.repeat_interleave(x, n, dim=axis))(v_cache[:, :, Sk - W:, :], rep, axis=1)
        scores = torch.einsum("bhqd,bhkd->bhqk", q, k) * (Dh ** -0.5)
        p = _softmax(scores, axis=-1)
        o = torch.einsum("bhqk,bhkd->bhqd", p, v)
        return (lambda x, *d: x.permute(*d))(o, 0, 2, 1, 3).reshape(B, Sq, Hq * Dh) @ wo

    def _B_ref(x, w1, b1, w2):
        h = torch.einsum("bsd,df->bsf", x, w1) + b1
        sp = torch.log1p(torch.exp(-torch.abs(h))) + torch.where(h > 0, h, torch.zeros_like(h))
        act = h * torch.tanh(sp)
        return torch.einsum("bsf,fd->bsd", act, w2)

    x = A_x
    xn = _layernorm(x, axis=-1)
    return x + _A_ref(xn, A_k_cache, A_v_cache, A_wq, A_wo) + _B_ref(xn, B_w1, B_b1, B_w2)
```

```asm
; @launch grid=(256,1,1) block=(384,1,1) lds=123392
.amdgcn_target "amdgcn-amd-amdhsa--gfx950"
.text
.globl parallel_sum__sliding_block_cached__dense_activation_mish__decode_kernel
.p2align 8
.type parallel_sum__sliding_block_cached__dense_activation_mish__decode_kernel,@function
parallel_sum__sliding_block_cached__dense_activation_mish__decode_kernel:
    s_load_dwordx16 s[4:19], s[0:1], 0
    s_load_dwordx8 s[20:27], s[0:1], 64
    s_getpc_b64 s[30:31]
L_pc:
    s_cmpk_ge_u32 s2, 256
    s_cbranch_scc1 L_end
    v_xor_b32 v2, 0x140, v0
    v_readfirstlane_b32 s3, v0
    v_lshlrev_b32 v2, 7, v2
    v_min_u32 v2, L_end-L_pc, v2
    global_load_dword v125, v2, s[30:31]
    s_cmp_eq_u32 s3, 0
    s_cbranch_scc0 L_notloader
    v_lshrrev_b32 v2, 3, v0
    v_and_b32 v9, 6, v2
    v_xor_b32 v9, v9, v0
    v_and_b32 v9, 7, v9
    v_lshlrev_b32 v9, 4, v9
    v_lshrrev_b32 v4, 5, v0
    v_and_b32 v5, 3, v2
    v_lshl_add_u32 v6, v4, 3, v5
    v_lshl_add_u32 v10, v6, 13, v9
    v_add_u32 v11, 31744, v10
    v_lshlrev_b32 v21, 4, v0
    s_mov_b32 s34, -1
    s_mov_b32 s35, 0x00020000
    s_movk_i32 s60, 0x800
    s_and_b32 s28, s2, 7
    s_lshr_b32 s29, s2, 3
    s_lshr_b32 s57, s2, 6
    s_lshl_b32 s57, s57, 10
    s_or_b32 s57, s57, s28
    s_lshl_b32 s57, s57, 3
    s_and_b32 s58, s29, 7
    s_or_b32 s57, s57, s58
    s_lshl_b32 s57, s57, 7
    s_lshl_b32 s59, s60, 6
    s_mov_b32 m0, 121344
    s_waitcnt lgkmcnt(0)
    global_load_lds_dwordx4 v21, s[4:5]
    global_load_lds_dwordx4 v21, s[4:5] offset:1024
    s_lshl_b32 m0, s60, 5
    s_mov_b64 s[32:33], s[10:11]
L_wq:
    buffer_load_dwordx4 v10, s[32:35], s57 offen nt lds
    buffer_load_dwordx4 v11, s[32:35], s57 offen offset:1024 nt lds
    s_add_u32 m0, m0, s60
    s_add_u32 s57, s57, s59
    s_bitcmp0_b32 m0, 14
    s_cbranch_scc1 L_wq
L_after256:
    s_setprio 3
    s_and_b32 s61, s29, 3
    s_lshl_b32 s62, s61, 3
    s_add_u32 s62, s62, s28
    s_lshr_b32 s63, s29, 2
    v_mul_u32_u24 v12, 3584, v6
    v_add_u32 v12, v12, v9
    v_add_u32 v13, 13312, v12
    s_mov_b32 s36, s16
    s_mov_b32 s37, s17
    s_cmp_lt_u32 s62, 28
    s_cselect_b32 s38, 1835008, 0
    s_mov_b32 s39, 0x00020000
    s_mul_i32 s57, s63, 229376
    s_lshl_b32 s58, s62, 7
    s_add_u32 s57, s57, s58
    s_lshl_b32 s56, s61, 11
    s_add_u32 m0, s56, 98304
    s_mul_i32 s58, s56, 28
    s_add_u32 s58, s58, s57
    buffer_load_dwordx4 v12, s[36:39], s58 offen nt lds
    buffer_load_dwordx4 v13, s[36:39], s58 offen offset:1024 nt lds
    s_add_u32 s56, s56, s60
    s_and_b32 s56, s56, 8191
    s_add_u32 m0, s56, 98304
    s_mul_i32 s58, s56, 28
    s_add_u32 s58, s58, s57
    buffer_load_dwordx4 v12, s[36:39], s58 offen nt lds
    buffer_load_dwordx4 v13, s[36:39], s58 offen offset:1024 nt lds
    s_add_u32 s56, s56, s60
    s_and_b32 s56, s56, 8191
    v_mov_b32 v20, 117760
    s_barrier
    s_waitcnt vmcnt(20)
    s_mov_b64 exec, 1
    ds_write_b32 v20, v20 offset:36
    s_mov_b64 exec, -1
    s_add_u32 m0, s56, 98304
    s_mul_i32 s58, s56, 28
    s_add_u32 s58, s58, s57
    buffer_load_dwordx4 v12, s[36:39], s58 offen nt lds
    buffer_load_dwordx4 v13, s[36:39], s58 offen offset:1024 nt lds
    s_add_u32 s56, s56, s60
    s_and_b32 s56, s56, 8191
    s_waitcnt vmcnt(20)
    s_add_u32 m0, s56, 98304
    s_mul_i32 s58, s56, 28
    s_add_u32 s58, s58, s57
    buffer_load_dwordx4 v12, s[36:39], s58 offen nt lds
    buffer_load_dwordx4 v13, s[36:39], s58 offen offset:1024 nt lds
    v_lshrrev_b32 v7, 4, v0
    v_lshlrev_b32 v8, 1, v7
    v_xor_b32 v8, v8, v0
    v_and_b32 v8, 15, v8
    v_lshlrev_b32 v8, 4, v8
    v_lshl_add_u32 v14, v7, 8, v8
    v_xor_b32 v15, 128, v14
    s_mov_b32 s40, s6
    s_mov_b32 s41, s7
    s_mov_b32 s42, 33554432
    s_mov_b32 s43, 0x00020000
    s_lshr_b32 s64, s29, 4
    s_lshl_b32 s64, s64, 3
    s_add_u32 s64, s64, s28
    s_lshl_b32 s64, s64, 21
    s_and_b32 s58, s29, 15
    s_lshl_b32 s58, s58, 15
    s_add_u32 s64, s64, s58
    s_add_u32 s64, s64, 1572864
    s_and_b32 s67, s29, 15
    s_lshl_b32 s56, s67, 11
    s_waitcnt vmcnt(20)
    s_mov_b32 m0, s56
    s_add_u32 s58, s56, s64
    buffer_load_dwordx4 v14, s[40:43], s58 offen nt lds
    buffer_load_dwordx4 v15, s[40:43], s58 offen offset:1024 nt lds
    s_add_u32 s56, s56, s60
    s_and_b32 s56, s56, 32767
    s_waitcnt vmcnt(20)
    s_mov_b32 m0, s56
    s_add_u32 s58, s56, s64
    buffer_load_dwordx4 v14, s[40:43], s58 offen nt lds
    buffer_load_dwordx4 v15, s[40:43], s58 offen offset:1024 nt lds
    s_add_u32 s56, s56, s60
    s_and_b32 s56, s56, 32767
    s_waitcnt vmcnt(20)
    s_mov_b32 m0, s56
    s_add_u32 s58, s56, s64
    buffer_load_dwordx4 v14, s[40:43], s58 offen nt lds
    buffer_load_dwordx4 v15, s[40:43], s58 offen offset:1024 nt lds
    s_add_u32 s56, s56, s60
    s_and_b32 s56, s56, 32767
    s_waitcnt vmcnt(20)
    s_mov_b32 m0, s56
    s_add_u32 s58, s56, s64
    buffer_load_dwordx4 v14, s[40:43], s58 offen nt lds
    buffer_load_dwordx4 v15, s[40:43], s58 offen offset:1024 nt lds
    s_add_u32 s56, s56, s60
    s_and_b32 s56, s56, 32767
    s_waitcnt vmcnt(20)
    s_mov_b32 m0, s56
    s_add_u32 s58, s56, s64
    buffer_load_dwordx4 v14, s[40:43], s58 offen nt lds
    buffer_load_dwordx4 v15, s[40:43], s58 offen offset:1024 nt lds
    s_add_u32 s56, s56, s60
    s_and_b32 s56, s56, 32767
    s_waitcnt vmcnt(20)
    s_mov_b32 m0, s56
    s_add_u32 s58, s56, s64
    buffer_load_dwordx4 v14, s[40:43], s58 offen nt lds
    buffer_load_dwordx4 v15, s[40:43], s58 offen offset:1024 nt lds
    s_add_u32 s56, s56, s60
    s_and_b32 s56, s56, 32767
    s_waitcnt vmcnt(20)
    s_mov_b64 exec, 1
    ds_write_b32 v20, v20 offset:0
    s_mov_b64 exec, -1
    s_mov_b32 m0, s56
    s_add_u32 s58, s56, s64
    buffer_load_dwordx4 v14, s[40:43], s58 offen nt lds
    buffer_load_dwordx4 v15, s[40:43], s58 offen offset:1024 nt lds
    s_add_u32 s56, s56, s60
    s_and_b32 s56, s56, 32767
    s_waitcnt vmcnt(20)
    s_mov_b32 m0, s56
    s_add_u32 s58, s56, s64
    buffer_load_dwordx4 v14, s[40:43], s58 offen nt lds
    buffer_load_dwordx4 v15, s[40:43], s58 offen offset:1024 nt lds
    s_add_u32 s56, s56, s60
    s_and_b32 s56, s56, 32767
    s_waitcnt vmcnt(20)
    s_mov_b32 m0, s56
    s_add_u32 s58, s56, s64
    buffer_load_dwordx4 v14, s[40:43], s58 offen nt lds
    buffer_load_dwordx4 v15, s[40:43], s58 offen offset:1024 nt lds
    s_add_u32 s56, s56, s60
    s_and_b32 s56, s56, 32767
    s_waitcnt vmcnt(20)
    s_mov_b32 m0, s56
    s_add_u32 s58, s56, s64
    buffer_load_dwordx4 v14, s[40:43], s58 offen nt lds
    buffer_load_dwordx4 v15, s[40:43], s58 offen offset:1024 nt lds
    s_add_u32 s56, s56, s60
    s_and_b32 s56, s56, 32767
    s_waitcnt vmcnt(20)
    s_mov_b64 exec, 1
    ds_write_b32 v20, v20 offset:4
    s_mov_b64 exec, -1
    s_mov_b32 m0, s56
    s_add_u32 s58, s56, s64
    buffer_load_dwordx4 v14, s[40:43], s58 offen nt lds
    buffer_load_dwordx4 v15, s[40:43], s58 offen offset:1024 nt lds
    s_add_u32 s56, s56, s60
    s_and_b32 s56, s56, 32767
    s_waitcnt vmcnt(20)
    s_mov_b32 m0, s56
    s_add_u32 s58, s56, s64
    buffer_load_dwordx4 v14, s[40:43], s58 offen nt lds
    buffer_load_dwordx4 v15, s[40:43], s58 offen offset:1024 nt lds
    s_add_u32 s56, s56, s60
    s_and_b32 s56, s56, 32767
    s_waitcnt vmcnt(20)
    s_mov_b32 m0, s56
    s_add_u32 s58, s56, s64
    buffer_load_dwordx4 v14, s[40:43], s58 offen nt lds
    buffer_load_dwordx4 v15, s[40:43], s58 offen offset:1024 nt lds
    s_add_u32 s56, s56, s60
    s_and_b32 s56, s56, 32767
    s_waitcnt vmcnt(20)
    s_mov_b32 m0, s56
    s_add_u32 s58, s56, s64
    buffer_load_dwordx4 v14, s[40:43], s58 offen nt lds
    buffer_load_dwordx4 v15, s[40:43], s58 offen offset:1024 nt lds
    s_add_u32 s56, s56, s60
    s_and_b32 s56, s56, 32767
    s_waitcnt vmcnt(20)
    s_mov_b32 m0, s56
    s_add_u32 s58, s56, s64
    buffer_load_dwordx4 v14, s[40:43], s58 offen nt lds
    buffer_load_dwordx4 v15, s[40:43], s58 offen offset:1024 nt lds
    s_add_u32 s56, s56, s60
    s_and_b32 s56, s56, 32767
    s_waitcnt vmcnt(20)
    s_mov_b32 m0, s56
    s_add_u32 s58, s56, s64
    buffer_load_dwordx4 v14, s[40:43], s58 offen nt lds
    buffer_load_dwordx4 v15, s[40:43], s58 offen offset:1024 nt lds
    s_mov_b32 s44, s8
    s_mov_b32 s45, s9
    s_mov_b32 s46, 33554432
    s_mov_b32 s47, 0x00020000
    s_lshl_b32 s65, s61, 13
    s_and_b32 s66, s63, 3
    s_lshl_b32 s66, s66, 11
    s_or_b32 s56, s65, s66
    s_waitcnt vmcnt(20)
    s_add_u32 m0, s56, 32768
    s_add_u32 s58, s56, s64
    buffer_load_dwordx4 v14, s[44:47], s58 offen nt lds
    buffer_load_dwordx4 v15, s[44:47], s58 offen offset:1024 nt lds
    s_add_u32 s66, s66, s60
    s_and_b32 s66, s66, 0x1fff
    s_or_b32 s56, s65, s66
    s_waitcnt vmcnt(20)
    s_add_u32 m0, s56, 32768
    s_add_u32 s58, s56, s64
    buffer_load_dwordx4 v14, s[44:47], s58 offen nt lds
    buffer_load_dwordx4 v15, s[44:47], s58 offen offset:1024 nt lds
    s_add_u32 s66, s66, s60
    s_and_b32 s66, s66, 0x1fff
    s_or_b32 s56, s65, s66
    s_waitcnt vmcnt(20)
    s_add_u32 m0, s56, 32768
    s_add_u32 s58, s56, s64
    buffer_load_dwordx4 v14, s[44:47], s58 offen nt lds
    buffer_load_dwordx4 v15, s[44:47], s58 offen offset:1024 nt lds
    s_add_u32 s66, s66, s60
    s_and_b32 s66, s66, 0x1fff
    s_or_b32 s56, s65, s66
    s_waitcnt vmcnt(20)
    s_add_u32 m0, s56, 32768
    s_add_u32 s58, s56, s64
    buffer_load_dwordx4 v14, s[44:47], s58 offen nt lds
    buffer_load_dwordx4 v15, s[44:47], s58 offen offset:1024 nt lds
    s_add_u32 s66, s66, s60
    s_and_b32 s66, s66, 0x1fff
    s_add_u32 s65, s65, 0x2000
    s_and_b32 s65, s65, 0x7fff
    s_or_b32 s56, s65, s66
    s_waitcnt vmcnt(20)
    s_add_u32 m0, s56, 32768
    s_add_u32 s58, s56, s64
    buffer_load_dwordx4 v14, s[44:47], s58 offen nt lds
    buffer_load_dwordx4 v15, s[44:47], s58 offen offset:1024 nt lds
    s_add_u32 s66, s66, s60
    s_and_b32 s66, s66, 0x1fff
    s_or_b32 s56, s65, s66
    s_waitcnt vmcnt(20)
    s_add_u32 m0, s56, 32768
    s_add_u32 s58, s56, s64
    buffer_load_dwordx4 v14, s[44:47], s58 offen nt lds
    buffer_load_dwordx4 v15, s[44:47], s58 offen offset:1024 nt lds
    s_add_u32 s66, s66, s60
    s_and_b32 s66, s66, 0x1fff
    s_or_b32 s56, s65, s66
    s_waitcnt vmcnt(20)
    s_add_u32 m0, s56, 32768
    s_add_u32 s58, s56, s64
    buffer_load_dwordx4 v14, s[44:47], s58 offen nt lds
    buffer_load_dwordx4 v15, s[44:47], s58 offen offset:1024 nt lds
    s_add_u32 s66, s66, s60
    s_and_b32 s66, s66, 0x1fff
    s_or_b32 s56, s65, s66
    s_waitcnt vmcnt(20)
    s_add_u32 m0, s56, 32768
    s_add_u32 s58, s56, s64
    buffer_load_dwordx4 v14, s[44:47], s58 offen nt lds
    buffer_load_dwordx4 v15, s[44:47], s58 offen offset:1024 nt lds
    s_add_u32 s66, s66, s60
    s_and_b32 s66, s66, 0x1fff
    s_add_u32 s65, s65, 0x2000
    s_and_b32 s65, s65, 0x7fff
    s_or_b32 s56, s65, s66
    s_waitcnt vmcnt(20)
    s_add_u32 m0, s56, 32768
    s_add_u32 s58, s56, s64
    buffer_load_dwordx4 v14, s[44:47], s58 offen nt lds
    buffer_load_dwordx4 v15, s[44:47], s58 offen offset:1024 nt lds
    s_add_u32 s66, s66, s60
    s_and_b32 s66, s66, 0x1fff
    s_or_b32 s56, s65, s66
    s_waitcnt vmcnt(20)
    s_add_u32 m0, s56, 32768
    s_add_u32 s58, s56, s64
    buffer_load_dwordx4 v14, s[44:47], s58 offen nt lds
    buffer_load_dwordx4 v15, s[44:47], s58 offen offset:1024 nt lds
    s_add_u32 s66, s66, s60
    s_and_b32 s66, s66, 0x1fff
    s_or_b32 s56, s65, s66
    s_waitcnt vmcnt(20)
    s_mov_b64 exec, 1
    ds_write_b32 v20, v20 offset:8
    s_mov_b64 exec, -1
    s_bitcmp1_b32 1, s28
    s_cbranch_scc1 L_deep78
    s_add_u32 m0, s56, 32768
    s_add_u32 s58, s56, s64
    buffer_load_dwordx4 v14, s[44:47], s58 offen nt lds
    buffer_load_dwordx4 v15, s[44:47], s58 offen offset:1024 nt lds
    s_add_u32 s66, s66, s60
    s_and_b32 s66, s66, 0x1fff
    s_or_b32 s56, s65, s66
    s_waitcnt vmcnt(20)
    s_add_u32 m0, s56, 32768
    s_add_u32 s58, s56, s64
    buffer_load_dwordx4 v14, s[44:47], s58 offen nt lds
    buffer_load_dwordx4 v15, s[44:47], s58 offen offset:1024 nt lds
    s_add_u32 s66, s66, s60
    s_and_b32 s66, s66, 0x1fff
    s_add_u32 s65, s65, 0x2000
    s_and_b32 s65, s65, 0x7fff
    s_or_b32 s56, s65, s66
    s_waitcnt vmcnt(20)
    s_add_u32 m0, s56, 32768
    s_add_u32 s58, s56, s64
    buffer_load_dwordx4 v14, s[44:47], s58 offen nt lds
    buffer_load_dwordx4 v15, s[44:47], s58 offen offset:1024 nt lds
    s_add_u32 s66, s66, s60
    s_and_b32 s66, s66, 0x1fff
    s_or_b32 s56, s65, s66
    s_waitcnt vmcnt(20)
    s_add_u32 m0, s56, 32768
    s_add_u32 s58, s56, s64
    buffer_load_dwordx4 v14, s[44:47], s58 offen nt lds
    buffer_load_dwordx4 v15, s[44:47], s58 offen offset:1024 nt lds
    s_add_u32 s66, s66, s60
    s_and_b32 s66, s66, 0x1fff
    s_or_b32 s56, s65, s66
    s_waitcnt vmcnt(20)
    s_mov_b64 exec, 1
    ds_write_b32 v20, v20 offset:44
    s_mov_b64 exec, -1
    s_add_u32 m0, s56, 32768
    s_add_u32 s58, s56, s64
    buffer_load_dwordx4 v14, s[44:47], s58 offen nt lds
    buffer_load_dwordx4 v15, s[44:47], s58 offen offset:1024 nt lds
    s_add_u32 s66, s66, s60
    s_and_b32 s66, s66, 0x1fff
    s_or_b32 s56, s65, s66
    s_waitcnt vmcnt(20)
    s_add_u32 m0, s56, 32768
    s_add_u32 s58, s56, s64
    buffer_load_dwordx4 v14, s[44:47], s58 offen nt lds
    buffer_load_dwordx4 v15, s[44:47], s58 offen offset:1024 nt lds
    v_lshl_add_u32 v18, v6, 10, v9
    v_add_u32 v19, 3072, v18
    s_mov_b32 s52, s20
    s_mov_b32 s53, s21
    s_cmp_lt_u32 s62, 28
    s_cselect_b32 s54, 1835008, 0
    s_mov_b32 s55, 0x00020000
    s_lshl_b32 s57, s62, 16
    s_lshl_b32 s58, s63, 7
    s_add_u32 s57, s57, s58
    s_lshl_b32 s56, s61, 11
    s_waitcnt vmcnt(20)
    s_add_u32 m0, s56, 106496
    s_lshl_b32 s58, s56, 3
    s_add_u32 s58, s58, s57
    buffer_load_dwordx4 v18, s[52:55], s58 offen nt lds
    buffer_load_dwordx4 v19, s[52:55], s58 offen offset:1024 nt lds
    s_add_u32 s56, s56, s60
    s_and_b32 s56, s56, 8191
    s_waitcnt vmcnt(20)
    s_add_u32 m0, s56, 106496
    s_lshl_b32 s58, s56, 3
    s_add_u32 s58, s58, s57
    buffer_load_dwordx4 v18, s[52:55], s58 offen nt lds
    buffer_load_dwordx4 v19, s[52:55], s58 offen offset:1024 nt lds
    s_add_u32 s56, s56, s60
    s_and_b32 s56, s56, 8191
    s_waitcnt vmcnt(20)
    s_mov_b64 exec, 1
    ds_write_b32 v20, v20 offset:48
    s_mov_b64 exec, -1
    s_add_u32 m0, s56, 106496
    s_lshl_b32 s58, s56, 3
    s_add_u32 s58, s58, s57
    buffer_load_dwordx4 v18, s[52:55], s58 offen nt lds
    buffer_load_dwordx4 v19, s[52:55], s58 offen offset:1024 nt lds
    s_add_u32 s56, s56, s60
    s_and_b32 s56, s56, 8191
    s_waitcnt vmcnt(20)
    s_add_u32 m0, s56, 106496
    s_lshl_b32 s58, s56, 3
    s_add_u32 s58, s58, s57
    buffer_load_dwordx4 v18, s[52:55], s58 offen nt lds
    buffer_load_dwordx4 v19, s[52:55], s58 offen offset:1024 nt lds
    v_lshl_add_u32 v7, v4, 7, v5
    v_lshl_add_u32 v16, v7, 10, v9
    v_add_u32 v17, 15360, v16
    s_mov_b32 s48, s12
    s_mov_b32 s49, s13
    s_mov_b32 s50, 4194304
    s_mov_b32 s51, 0x00020000
    s_lshl_b32 s57, s28, 19
    s_lshl_b32 s58, s61, 15
    s_add_u32 s57, s57, s58
    s_lshl_b32 s58, s63, 7
    s_add_u32 s57, s57, s58
    s_and_b32 s56, s29, 7
    s_lshl_b32 s56, s56, 11
    s_waitcnt vmcnt(20)
    s_add_u32 m0, s56, 81920
    s_and_b32 s58, s56, s60
    s_lshl_b32 s58, s58, 7
    s_and_b32 s59, s56, 0x3000
    s_add_u32 s58, s58, s59
    s_add_u32 s58, s58, s57
    buffer_load_dwordx4 v16, s[48:51], s58 offen nt lds
    buffer_load_dwordx4 v17, s[48:51], s58 offen offset:1024 nt lds
    s_add_u32 s56, s56, s60
    s_and_b32 s56, s56, 16383
    s_waitcnt vmcnt(20)
    s_add_u32 m0, s56, 81920
    s_and_b32 s58, s56, s60
    s_lshl_b32 s58, s58, 7
    s_and_b32 s59, s56, 0x3000
    s_add_u32 s58, s58, s59
    s_add_u32 s58, s58, s57
    buffer_load_dwordx4 v16, s[48:51], s58 offen nt lds
    buffer_load_dwordx4 v17, s[48:51], s58 offen offset:1024 nt lds
    s_add_u32 s56, s56, s60
    s_and_b32 s56, s56, 16383
    s_waitcnt vmcnt(20)
    s_mov_b64 exec, 1
    ds_write_b32 v20, v20 offset:52
    s_mov_b64 exec, -1
    s_add_u32 m0, s56, 81920
    s_and_b32 s58, s56, s60
    s_lshl_b32 s58, s58, 7
    s_and_b32 s59, s56, 0x3000
    s_add_u32 s58, s58, s59
    s_add_u32 s58, s58, s57
    buffer_load_dwordx4 v16, s[48:51], s58 offen nt lds
    buffer_load_dwordx4 v17, s[48:51], s58 offen offset:1024 nt lds
    s_add_u32 s56, s56, s60
    s_and_b32 s56, s56, 16383
    s_waitcnt vmcnt(20)
    s_add_u32 m0, s56, 81920
    s_and_b32 s58, s56, s60
    s_lshl_b32 s58, s58, 7
    s_and_b32 s59, s56, 0x3000
    s_add_u32 s58, s58, s59
    s_add_u32 s58, s58, s57
    buffer_load_dwordx4 v16, s[48:51], s58 offen nt lds
    buffer_load_dwordx4 v17, s[48:51], s58 offen offset:1024 nt lds
    s_add_u32 s56, s56, s60
    s_and_b32 s56, s56, 16383
    s_waitcnt vmcnt(20)
    s_add_u32 m0, s56, 81920
    s_and_b32 s58, s56, s60
    s_lshl_b32 s58, s58, 7
    s_and_b32 s59, s56, 0x3000
    s_add_u32 s58, s58, s59
    s_add_u32 s58, s58, s57
    buffer_load_dwordx4 v16, s[48:51], s58 offen nt lds
    buffer_load_dwordx4 v17, s[48:51], s58 offen offset:1024 nt lds
    s_add_u32 s56, s56, s60
    s_and_b32 s56, s56, 16383
    s_waitcnt vmcnt(20)
    s_add_u32 m0, s56, 81920
    s_and_b32 s58, s56, s60
    s_lshl_b32 s58, s58, 7
    s_and_b32 s59, s56, 0x3000
    s_add_u32 s58, s58, s59
    s_add_u32 s58, s58, s57
    buffer_load_dwordx4 v16, s[48:51], s58 offen nt lds
    buffer_load_dwordx4 v17, s[48:51], s58 offen offset:1024 nt lds
    s_add_u32 s56, s56, s60
    s_and_b32 s56, s56, 16383
    s_waitcnt vmcnt(20)
    s_mov_b64 exec, 1
    ds_write_b32 v20, v20 offset:12
    s_mov_b64 exec, -1
    s_add_u32 m0, s56, 81920
    s_and_b32 s58, s56, s60
    s_lshl_b32 s58, s58, 7
    s_and_b32 s59, s56, 0x3000
    s_add_u32 s58, s58, s59
    s_add_u32 s58, s58, s57
    buffer_load_dwordx4 v16, s[48:51], s58 offen nt lds
    buffer_load_dwordx4 v17, s[48:51], s58 offen offset:1024 nt lds
    s_add_u32 s56, s56, s60
    s_and_b32 s56, s56, 16383
    s_waitcnt vmcnt(20)
    s_add_u32 m0, s56, 81920
    s_and_b32 s58, s56, s60
    s_lshl_b32 s58, s58, 7
    s_and_b32 s59, s56, 0x3000
    s_add_u32 s58, s58, s59
    s_add_u32 s58, s58, s57
    buffer_load_dwordx4 v16, s[48:51], s58 offen nt lds
    buffer_load_dwordx4 v17, s[48:51], s58 offen offset:1024 nt lds
    s_waitcnt vmcnt(16)
    s_mov_b64 exec, 1
    ds_write_b32 v20, v20 offset:20
    s_mov_b64 exec, -1
    s_waitcnt vmcnt(0)
    s_mov_b64 exec, 1
    ds_write_b32 v20, v20 offset:16
    s_mov_b64 exec, -1
    s_endpgm
L_deep78:
    s_waitcnt vmcnt(26)
    s_add_u32 m0, s56, 32768
    s_add_u32 s58, s56, s64
    buffer_load_dwordx4 v14, s[44:47], s58 offen nt lds
    buffer_load_dwordx4 v15, s[44:47], s58 offen offset:1024 nt lds
    s_add_u32 s66, s66, s60
    s_and_b32 s66, s66, 0x1fff
    s_or_b32 s56, s65, s66
    s_waitcnt vmcnt(26)
    s_add_u32 m0, s56, 32768
    s_add_u32 s58, s56, s64
    buffer_load_dwordx4 v14, s[44:47], s58 offen nt lds
    buffer_load_dwordx4 v15, s[44:47], s58 offen offset:1024 nt lds
    s_add_u32 s66, s66, s60
    s_and_b32 s66, s66, 0x1fff
    s_add_u32 s65, s65, 0x2000
    s_and_b32 s65, s65, 0x7fff
    s_or_b32 s56, s65, s66
    s_waitcnt vmcnt(26)
    s_add_u32 m0, s56, 32768
    s_add_u32 s58, s56, s64
    buffer_load_dwordx4 v14, s[44:47], s58 offen nt lds
    buffer_load_dwordx4 v15, s[44:47], s58 offen offset:1024 nt lds
    s_add_u32 s66, s66, s60
    s_and_b32 s66, s66, 0x1fff
    s_or_b32 s56, s65, s66
    s_waitcnt vmcnt(26)
    s_mov_b64 exec, 1
    ds_write_b32 v20, v20 offset:8
    s_mov_b64 exec, -1
    s_add_u32 m0, s56, 32768
    s_add_u32 s58, s56, s64
    buffer_load_dwordx4 v14, s[44:47], s58 offen nt lds
    buffer_load_dwordx4 v15, s[44:47], s58 offen offset:1024 nt lds
    s_add_u32 s66, s66, s60
    s_and_b32 s66, s66, 0x1fff
    s_or_b32 s56, s65, s66
    s_waitcnt vmcnt(26)
    s_add_u32 m0, s56, 32768
    s_add_u32 s58, s56, s64
    buffer_load_dwordx4 v14, s[44:47], s58 offen nt lds
    buffer_load_dwordx4 v15, s[44:47], s58 offen offset:1024 nt lds
    s_add_u32 s66, s66, s60
    s_and_b32 s66, s66, 0x1fff
    s_or_b32 s56, s65, s66
    s_waitcnt vmcnt(26)
    s_add_u32 m0, s56, 32768
    s_add_u32 s58, s56, s64
    buffer_load_dwordx4 v14, s[44:47], s58 offen nt lds
    buffer_load_dwordx4 v15, s[44:47], s58 offen offset:1024 nt lds
    v_lshl_add_u32 v18, v6, 10, v9
    v_add_u32 v19, 3072, v18
    s_mov_b32 s52, s20
    s_mov_b32 s53, s21
    s_cmp_lt_u32 s62, 28
    s_cselect_b32 s54, 1835008, 0
    s_mov_b32 s55, 0x00020000
    s_lshl_b32 s57, s62, 16
    s_lshl_b32 s58, s63, 7
    s_add_u32 s57, s57, s58
    s_lshl_b32 s56, s61, 11
    s_waitcnt vmcnt(26)
    s_add_u32 m0, s56, 106496
    s_lshl_b32 s58, s56, 3
    s_add_u32 s58, s58, s57
    buffer_load_dwordx4 v18, s[52:55], s58 offen nt lds
    buffer_load_dwordx4 v19, s[52:55], s58 offen offset:1024 nt lds
    s_add_u32 s56, s56, s60
    s_and_b32 s56, s56, 8191
    s_waitcnt vmcnt(26)
    s_mov_b64 exec, 1
    ds_write_b32 v20, v20 offset:44
    s_mov_b64 exec, -1
    s_add_u32 m0, s56, 106496
    s_lshl_b32 s58, s56, 3
    s_add_u32 s58, s58, s57
    buffer_load_dwordx4 v18, s[52:55], s58 offen nt lds
    buffer_load_dwordx4 v19, s[52:55], s58 offen offset:1024 nt lds
    s_add_u32 s56, s56, s60
    s_and_b32 s56, s56, 8191
    s_waitcnt vmcnt(26)
    s_add_u32 m0, s56, 106496
    s_lshl_b32 s58, s56, 3
    s_add_u32 s58, s58, s57
    buffer_load_dwordx4 v18, s[52:55], s58 offen nt lds
    buffer_load_dwordx4 v19, s[52:55], s58 offen offset:1024 nt lds
    s_add_u32 s56, s56, s60
    s_and_b32 s56, s56, 8191
    s_waitcnt vmcnt(26)
    s_add_u32 m0, s56, 106496
    s_lshl_b32 s58, s56, 3
    s_add_u32 s58, s58, s57
    buffer_load_dwordx4 v18, s[52:55], s58 offen nt lds
    buffer_load_dwordx4 v19, s[52:55], s58 offen offset:1024 nt lds
    v_lshl_add_u32 v7, v4, 7, v5
    v_lshl_add_u32 v16, v7, 10, v9
    v_add_u32 v17, 15360, v16
    s_mov_b32 s48, s12
    s_mov_b32 s49, s13
    s_mov_b32 s50, 4194304
    s_mov_b32 s51, 0x00020000
    s_lshl_b32 s57, s28, 19
    s_lshl_b32 s58, s61, 15
    s_add_u32 s57, s57, s58
    s_lshl_b32 s58, s63, 7
    s_add_u32 s57, s57, s58
    s_and_b32 s56, s29, 7
    s_lshl_b32 s56, s56, 11
    s_waitcnt vmcnt(26)
    s_add_u32 m0, s56, 81920
    s_and_b32 s58, s56, s60
    s_lshl_b32 s58, s58, 7
    s_and_b32 s59, s56, 0x3000
    s_add_u32 s58, s58, s59
    s_add_u32 s58, s58, s57
    buffer_load_dwordx4 v16, s[48:51], s58 offen nt lds
    buffer_load_dwordx4 v17, s[48:51], s58 offen offset:1024 nt lds
    s_add_u32 s56, s56, s60
    s_and_b32 s56, s56, 16383
    s_waitcnt vmcnt(26)
    s_mov_b64 exec, 1
    ds_write_b32 v20, v20 offset:48
    s_mov_b64 exec, -1
    s_add_u32 m0, s56, 81920
    s_and_b32 s58, s56, s60
    s_lshl_b32 s58, s58, 7
    s_and_b32 s59, s56, 0x3000
    s_add_u32 s58, s58, s59
    s_add_u32 s58, s58, s57
    buffer_load_dwordx4 v16, s[48:51], s58 offen nt lds
    buffer_load_dwordx4 v17, s[48:51], s58 offen offset:1024 nt lds
    s_add_u32 s56, s56, s60
    s_and_b32 s56, s56, 16383
    s_waitcnt vmcnt(26)
    s_add_u32 m0, s56, 81920
    s_and_b32 s58, s56, s60
    s_lshl_b32 s58, s58, 7
    s_and_b32 s59, s56, 0x3000
    s_add_u32 s58, s58, s59
    s_add_u32 s58, s58, s57
    buffer_load_dwordx4 v16, s[48:51], s58 offen nt lds
    buffer_load_dwordx4 v17, s[48:51], s58 offen offset:1024 nt lds
    s_add_u32 s56, s56, s60
    s_and_b32 s56, s56, 16383
    s_waitcnt vmcnt(26)
    s_add_u32 m0, s56, 81920
    s_and_b32 s58, s56, s60
    s_lshl_b32 s58, s58, 7
    s_and_b32 s59, s56, 0x3000
    s_add_u32 s58, s58, s59
    s_add_u32 s58, s58, s57
    buffer_load_dwordx4 v16, s[48:51], s58 offen nt lds
    buffer_load_dwordx4 v17, s[48:51], s58 offen offset:1024 nt lds
    s_add_u32 s56, s56, s60
    s_and_b32 s56, s56, 16383
    s_waitcnt vmcnt(26)
    s_add_u32 m0, s56, 81920
    s_and_b32 s58, s56, s60
    s_lshl_b32 s58, s58, 7
    s_and_b32 s59, s56, 0x3000
    s_add_u32 s58, s58, s59
    s_add_u32 s58, s58, s57
    buffer_load_dwordx4 v16, s[48:51], s58 offen nt lds
    buffer_load_dwordx4 v17, s[48:51], s58 offen offset:1024 nt lds
    s_add_u32 s56, s56, s60
    s_and_b32 s56, s56, 16383
    s_waitcnt vmcnt(26)
    s_mov_b64 exec, 1
    ds_write_b32 v20, v20 offset:52
    s_mov_b64 exec, -1
    s_add_u32 m0, s56, 81920
    s_and_b32 s58, s56, s60
    s_lshl_b32 s58, s58, 7
    s_and_b32 s59, s56, 0x3000
    s_add_u32 s58, s58, s59
    s_add_u32 s58, s58, s57
    buffer_load_dwordx4 v16, s[48:51], s58 offen nt lds
    buffer_load_dwordx4 v17, s[48:51], s58 offen offset:1024 nt lds
    s_add_u32 s56, s56, s60
    s_and_b32 s56, s56, 16383
    s_waitcnt vmcnt(26)
    s_add_u32 m0, s56, 81920
    s_and_b32 s58, s56, s60
    s_lshl_b32 s58, s58, 7
    s_and_b32 s59, s56, 0x3000
    s_add_u32 s58, s58, s59
    s_add_u32 s58, s58, s57
    buffer_load_dwordx4 v16, s[48:51], s58 offen nt lds
    buffer_load_dwordx4 v17, s[48:51], s58 offen offset:1024 nt lds
    s_add_u32 s56, s56, s60
    s_and_b32 s56, s56, 16383
    s_waitcnt vmcnt(26)
    s_add_u32 m0, s56, 81920
    s_and_b32 s58, s56, s60
    s_lshl_b32 s58, s58, 7
    s_and_b32 s59, s56, 0x3000
    s_add_u32 s58, s58, s59
    s_add_u32 s58, s58, s57
    buffer_load_dwordx4 v16, s[48:51], s58 offen nt lds
    buffer_load_dwordx4 v17, s[48:51], s58 offen offset:1024 nt lds
    s_waitcnt vmcnt(24)
    s_mov_b64 exec, 1
    ds_write_b32 v20, v20 offset:12
    s_mov_b64 exec, -1
    s_waitcnt vmcnt(16)
    s_mov_b64 exec, 1
    ds_write_b32 v20, v20 offset:20
    s_mov_b64 exec, -1
    s_waitcnt vmcnt(0)
    s_mov_b64 exec, 1
    ds_write_b32 v20, v20 offset:16
    s_mov_b64 exec, -1
    s_endpgm
L_notloader:
    s_lshr_b32 s3, s3, 6
    v_and_b32 v0, 63, v0
    s_and_b32 s28, s2, 7
    s_lshr_b32 s29, s2, 3
    s_cmp_eq_u32 s3, 1
    s_cbranch_scc0 L_compute
    s_and_b32 s61, s29, 3
    s_lshl_b32 s62, s61, 3
    s_add_u32 s62, s62, s28
    v_and_b32 v11, 7, v0
    v_lshlrev_b32 v11, 2, v11
    v_lshrrev_b32 v12, 5, v0
    v_lshl_add_u32 v11, v12, 1, v11
    v_bfe_u32 v12, v0, 4, 1
    v_add_u32 v11, v11, v12
    v_bfe_u32 v12, v0, 3, 1
    v_lshl_add_u32 v11, v12, 5, v11
    s_min_u32 s63, s62, 27
    s_lshl_b32 s63, s63, 6
    v_add_u32 v13, s63, v11
    v_lshlrev_b32 v13, 1, v13
    v_mov_b32 v20, 117760
    v_mov_b32 v40, 0
    v_mov_b32 v41, 0
    v_mov_b32 v19, 0
    s_mov_b32 s100, 0
    s_mov_b32 s101, 0
    s_getreg_b32 s64, hwreg(HW_REG_XCC_ID)
    s_memrealtime s[76:77]
    s_lshl_b32 s65, s28, 17
    s_lshl_b32 s66, s29, 12
    s_add_u32 s66, s66, s65
    v_and_b32 v21, 31, v0
    v_lshlrev_b32 v21, 12, v21
    s_waitcnt lgkmcnt(0)
    s_load_dword s5, s[26:27], 0
    global_load_ushort v14, v13, s[18:19]
    s_add_u32 s8, s26, 65536
    s_addc_u32 s9, s27, 0
    s_mov_b32 s10, 0x300000
    s_mov_b32 s11, 0x00020000
    s_barrier
    s_and_b32 s64, s64, 15
    s_waitcnt lgkmcnt(0)
    s_add_u32 s5, s5, 1
    s_lshl_b32 s6, s5, 4
    s_or_b32 s6, s6, s64
    v_mov_b32 v22, s6
    v_lshlrev_b32 v24, 2, v0
    s_mov_b32 exec_lo, -1
    s_mov_b32 exec_hi, 0
    buffer_store_dword v22, v24, s[8:11], s66 offen offset:3200
    s_mov_b64 exec, -1
    v_and_b32 v70, 7, v0
    v_lshlrev_b32 v71, 7, v70
    s_mov_b32 s78, 1179648
    s_cmp_eq_u32 s29, 0
    s_cbranch_scc0 L_nost
    s_lshl_b32 s34, s28, 7
    s_add_u32 s34, s34, s78
    s_cmp_eq_u32 s28, 0
    s_cselect_b32 s35, 0, 0
    s_sub_u32 s76, s76, s35
    v_mov_b32 v26, s76
    v_mov_b32 v27, s5
    s_mov_b64 exec, 1
    buffer_store_dwordx2 v[26:27], v19, s[8:11], s34 offen sc1
    s_mov_b64 exec, -1
L_nost:
    v_lshrrev_b32 v5, 4, v0
    v_and_b32 v4, 15, v0
    v_bfe_u32 v60, v0, 2, 2
    v_and_b32 v17, 1, v5
    v_lshl_add_u32 v60, v17, 2, v60
    v_bfe_u32 v18, v0, 1, 1
    v_and_b32 v61, 6, v60
    v_xor_b32 v18, v18, v61
    v_lshlrev_b32 v18, 4, v18
    v_and_b32 v61, 1, v0
    v_lshl_add_u32 v18, v61, 3, v18
    v_lshrrev_b32 v17, 5, v0
    v_lshl_add_u32 v17, v17, 4, v60
    v_lshl_add_u32 v62, v17, 7, v18
    v_add_u32 v62, 98304, v62
    v_xor_b32 v63, 32, v62
    v_xor_b32 v64, 64, v62
    v_xor_b32 v65, 96, v62
    v_mul_u32_u24 v18, 1040, v61
    v_lshl_add_u32 v18, v5, 4, v18
    s_lshr_b32 s37, s29, 2
    s_lshl_b32 s37, s37, 7
    s_add_u32 s37, s37, 118784
    v_add_u32 v66, s37, v18
    v_lshlrev_b32 v67, 8, v4
    v_lshl_add_u32 v67, v5, 4, v67
    s_movk_i32 s53, 0xff00
    s_mov_b32 s48, 0x00030003
    s_mov_b32 s49, 0x00030003
    s_mov_b32 s72, s5
    s_lshr_b32 s73, s5, 8
    s_lshr_b32 s74, s5, 16
    s_lshr_b32 s75, s5, 24
    v_mov_b32 v156, 0xff
    v_and_b32 v152, s72, v156
    v_and_b32 v153, s73, v156
    v_and_b32 v154, s74, v156
    v_and_b32 v155, s75, v156
    v_and_b32 v157, 1, v0
    v_cmp_eq_u32 vcc, 0, v157
    s_nop 1
    v_cndmask_b32 v156, v154, v152, vcc
    v_cndmask_b32 v157, v155, v153, vcc
L_wf1:
    ds_read_b32 v18, v20 offset:56
    s_waitcnt lgkmcnt(0)
    v_cmp_eq_u32 vcc, -1, v18
    s_cbranch_vccnz L_wf1
    buffer_load_dword v23, v21, s[8:11], s65 offen offset:3200 sc1
    ds_read_b128 v[24:27], v66
    ds_read_b128 v[28:31], v66 offset:64
L_wf2:
    ds_read_b32 v18, v20 offset:4
    s_waitcnt lgkmcnt(0)
    v_cmp_eq_u32 vcc, -1, v18
    s_cbranch_vccnz L_wf2
    ds_read_b64_tr_b16 v[72:73], v62 offset:0
    ds_read_b64_tr_b16 v[74:75], v62 offset:1024
    ds_read_b64_tr_b16 v[76:77], v62 offset:4096
    ds_read_b64_tr_b16 v[78:79], v62 offset:5120
    ds_read_b64_tr_b16 v[80:81], v63 offset:0
    ds_read_b64_tr_b16 v[82:83], v63 offset:1024
    ds_read_b64_tr_b16 v[84:85], v63 offset:4096
    ds_read_b64_tr_b16 v[86:87], v63 offset:5120
    ds_read_b64_tr_b16 v[88:89], v64 offset:0
    ds_read_b64_tr_b16 v[90:91], v64 offset:1024
    ds_read_b64_tr_b16 v[92:93], v64 offset:4096
    ds_read_b64_tr_b16 v[94:95], v64 offset:5120
    ds_read_b64_tr_b16 v[96:97], v65 offset:0
    ds_read_b64_tr_b16 v[98:99], v65 offset:1024
    ds_read_b64_tr_b16 v[100:101], v65 offset:4096
    ds_read_b64_tr_b16 v[102:103], v65 offset:5120
    s_waitcnt lgkmcnt(12)
    v_mfma_f32_16x16x32_bf16 v[104:107], v[72:75], v[24:27], 0
    v_mfma_f32_16x16x32_bf16 v[104:107], v[76:79], v[28:31], v[104:107]
    s_waitcnt lgkmcnt(8)
    v_mfma_f32_16x16x32_bf16 v[108:111], v[80:83], v[24:27], 0
    v_mfma_f32_16x16x32_bf16 v[108:111], v[84:87], v[28:31], v[108:111]
    s_waitcnt lgkmcnt(4)
    v_mfma_f32_16x16x32_bf16 v[112:115], v[88:91], v[24:27], 0
    v_mfma_f32_16x16x32_bf16 v[112:115], v[92:95], v[28:31], v[112:115]
    s_waitcnt lgkmcnt(0)
    v_mfma_f32_16x16x32_bf16 v[116:119], v[96:99], v[24:27], 0
    v_mfma_f32_16x16x32_bf16 v[116:119], v[100:103], v[28:31], v[116:119]
    v_and_or_b32 v104, v104, s53, v152
    v_and_or_b32 v105, v105, s53, v153
    v_and_or_b32 v106, v106, s53, v154
    v_and_or_b32 v107, v107, s53, v155
    v_and_or_b32 v108, v108, s53, v152
    v_and_or_b32 v109, v109, s53, v153
    v_and_or_b32 v110, v110, s53, v154
    v_and_or_b32 v111, v111, s53, v155
    v_and_or_b32 v112, v112, s53, v152
    v_and_or_b32 v113, v113, s53, v153
    v_and_or_b32 v114, v114, s53, v154
    v_and_or_b32 v115, v115, s53, v155
    v_and_or_b32 v116, v116, s53, v152
    v_and_or_b32 v117, v117, s53, v153
    v_and_or_b32 v118, v118, s53, v154
    v_and_or_b32 v119, v119, s53, v155
    s_mov_b64 exec, s[48:49]
    buffer_store_dwordx4 v[104:107], v67, s[8:11], s66 offen offset:512
    buffer_store_dwordx4 v[108:111], v67, s[8:11], s66 offen offset:576
    buffer_store_dwordx4 v[112:115], v67, s[8:11], s66 offen offset:640
    buffer_store_dwordx4 v[116:119], v67, s[8:11], s66 offen offset:704
    s_mov_b64 exec, -1
    s_mov_b32 s7, 0
    s_waitcnt vmcnt(4)
    s_branch L_idchk
L_id3:
    buffer_load_dword v23, v21, s[8:11], s65 offen offset:3200 sc1
L_idw0:
    s_waitcnt vmcnt(0)
L_idchk:
    v_cmp_ne_u32 vcc, s6, v23
    s_cbranch_vccz L_idok
    s_add_u32 s7, s7, 1
    s_cmp_lt_u32 s7, 48
    s_cbranch_scc1 L_id3
L_idok:
    s_cmp_eq_u32 s7, 48
    s_cselect_b32 s7, 1, 0
    v_mov_b32 v23, s7
    s_mov_b64 exec, 1
    ds_write_b32 v20, v23 offset:40
    s_mov_b64 exec, -1
    v_lshlrev_b32 v25, 7, v0
    s_mov_b32 exec_lo, 33554176
    s_mov_b32 exec_hi, 0
    buffer_load_dword v124, v25, s[8:11], s66 offen
    s_mov_b64 exec, -1
    s_cmp_ge_u32 s62, 28
    s_cbranch_scc1 L_hpfast
    s_cmp_eq_u32 s7, 0
    s_cbranch_scc1 L_hpfast
    s_xor_b32 s37, s66, 2097152
    s_mov_b64 exec, s[48:49]
    buffer_store_dwordx4 v[104:107], v67, s[8:11], s37 offen offset:512 sc1
    buffer_store_dwordx4 v[108:111], v67, s[8:11], s37 offen offset:576 sc1
    buffer_store_dwordx4 v[112:115], v67, s[8:11], s37 offen offset:640 sc1
    buffer_store_dwordx4 v[116:119], v67, s[8:11], s37 offen offset:704 sc1
    s_mov_b64 exec, -1
L_hpfast:
    buffer_load_dwordx2 v[120:121], v71, s[8:11], s78 offen sc1
    s_cmp_lt_u32 s62, 28
    s_cbranch_scc0 L_actw
    v_lshrrev_b32 v16, 3, v0
    v_lshlrev_b32 v16, 14, v16
    v_and_b32 v17, 7, v0
    v_lshl_add_u32 v16, v17, 4, v16
    s_lshl_b32 s31, s61, 12
    s_add_u32 s31, s31, s65
    s_sleep 12
    s_lshl_b32 s7, s7, 21
L_hp4:
    s_xor_b32 s31, s31, s7
    buffer_load_dwordx4 v[24:27], v16, s[8:11], s31 offen offset:512 sc1
    buffer_load_dwordx4 v[28:31], v16, s[8:11], s31 offen offset:768 sc1
    buffer_load_dwordx4 v[32:35], v16, s[8:11], s31 offen offset:640 sc1
    buffer_load_dwordx4 v[36:39], v16, s[8:11], s31 offen offset:896 sc1
    s_waitcnt vmcnt(0)
    v_bitop3_b32 v44, v24, v28, s72 bitop3:0x7e
    v_bitop3_b32 v45, v25, v29, s73 bitop3:0x7e
    v_bitop3_b32 v46, v26, v30, s74 bitop3:0x7e
    v_bitop3_b32 v47, v27, v31, s75 bitop3:0x7e
    v_bitop3_b32 v48, v32, v36, s72 bitop3:0x7e
    v_bitop3_b32 v49, v33, v37, s73 bitop3:0x7e
    v_bitop3_b32 v50, v34, v38, s74 bitop3:0x7e
    v_bitop3_b32 v51, v35, v39, s75 bitop3:0x7e
    v_or3_b32 v44, v44, v45, v46
    v_or3_b32 v47, v47, v48, v49
    v_or3_b32 v50, v50, v51, v44
    v_or_b32 v47, v47, v50
    v_cmp_ne_u32_sdwa vcc, v47, v19 src0_sel:BYTE_0 src1_sel:DWORD
    s_cbranch_vccz L_ok5
    s_sleep 4
    s_add_u32 s101, s101, 1
    s_cmp_lt_u32 s101, 262144
    s_cbranch_scc1 L_hp4
L_ok5:
    v_permlane32_swap_b32 v24, v26
    v_permlane32_swap_b32 v25, v27
    v_add_f32 v24, v24, v26
    v_add_f32 v25, v25, v27
    v_permlane32_swap_b32 v28, v30
    v_permlane32_swap_b32 v29, v31
    v_add_f32 v28, v28, v30
    v_add_f32 v29, v29, v31
    v_permlane32_swap_b32 v32, v34
    v_permlane32_swap_b32 v33, v35
    v_add_f32 v32, v32, v34
    v_add_f32 v33, v33, v35
    v_permlane32_swap_b32 v36, v38
    v_permlane32_swap_b32 v37, v39
    v_add_f32 v36, v36, v38
    v_add_f32 v37, v37, v39
    v_permlane16_swap_b32 v24, v25
    v_add_f32 v24, v24, v25
    v_permlane16_swap_b32 v28, v29
    v_add_f32 v28, v28, v29
    v_permlane16_swap_b32 v32, v33
    v_add_f32 v32, v32, v33
    v_permlane16_swap_b32 v36, v37
    v_add_f32 v36, v36, v37
    v_add_f32 v24, v24, v24 row_ror:8
    v_add_f32 v28, v28, v28 row_ror:8
    v_add_f32 v32, v32, v32 row_ror:8
    v_add_f32 v36, v36, v36 row_ror:8
    v_and_b32 v18, 8, v0
    v_cmp_eq_u32 vcc, 0, v18
    s_nop 1
    v_cndmask_b32 v40, v32, v24, vcc
    v_cndmask_b32 v41, v36, v28, vcc
    v_lshlrev_b32 v14, 16, v14
    s_mov_b32 s32, 0x3fb8aa3b
    s_mov_b32 s33, 0x3f317218
    v_cvt_pk_bf16_f32 v40, v40, v40
    v_lshlrev_b32 v40, 16, v40
    v_add_f32 v40, v40, v14
    v_cvt_pk_bf16_f32 v40, v40, v40
    v_lshlrev_b32 v40, 16, v40
    v_mul_f32 v44, s32, v40
    v_exp_f32 v44, -abs(v44)
    s_nop 0
    v_cvt_pk_bf16_f32 v44, v44, v44
    v_lshlrev_b32 v44, 16, v44
    v_add_f32 v45, 1.0, v44
    v_log_f32 v46, v45
    v_add_f32 v47, -1.0, v45
    v_rcp_f32 v47, v47
    v_mul_f32 v46, s33, v46
    v_mul_f32 v46, v46, v44
    v_mul_f32 v46, v46, v47
    v_cmp_eq_f32 vcc, 1.0, v45
    s_nop 1
    v_cndmask_b32 v46, v46, v44, vcc
    v_cvt_pk_bf16_f32 v46, v46, v46
    v_lshlrev_b32 v46, 16, v46
    v_max_f32 v45, 0, v40
    v_add_f32 v46, v46, v45
    v_cvt_pk_bf16_f32 v46, v46, v46
    v_lshlrev_b32 v46, 16, v46
    v_mul_f32 v44, -2.0, v46
    v_mul_f32 v45, s32, v44
    v_exp_f32 v45, v45
    v_log_f32 v47, v45
    v_add_f32 v48, -1.0, v45
    v_mul_f32 v47, s33, v47
    v_rcp_f32 v47, v47
    v_mul_f32 v49, v48, v44
    v_mul_f32 v49, v49, v47
    v_cmp_eq_f32 vcc, 1.0, v45
    s_nop 1
    v_cndmask_b32 v49, v49, v44, vcc
    v_cmp_gt_f32 vcc, 0.5, v45
    s_nop 1
    v_cndmask_b32 v49, v49, v48, vcc
    v_add_f32 v48, 2.0, v49
    v_rcp_f32 v48, v48
    s_nop 0
    v_mul_f32 v49, v49, v48
    v_sub_f32 v49, 0, v49
    v_cvt_pk_bf16_f32 v49, v49, v49
    v_lshlrev_b32 v49, 16, v49
    v_mul_f32 v40, v40, v49
    v_cvt_pk_bf16_f32 v40, v40, v40
    v_cvt_pk_bf16_f32 v41, v41, v41
    v_lshlrev_b32 v41, 16, v41
    v_add_f32 v41, v41, v14
    v_cvt_pk_bf16_f32 v41, v41, v41
    v_lshlrev_b32 v41, 16, v41
    v_mul_f32 v44, s32, v41
    v_exp_f32 v44, -abs(v44)
    s_nop 0
    v_cvt_pk_bf16_f32 v44, v44, v44
    v_lshlrev_b32 v44, 16, v44
    v_add_f32 v45, 1.0, v44
    v_log_f32 v46, v45
    v_add_f32 v47, -1.0, v45
    v_rcp_f32 v47, v47
    v_mul_f32 v46, s33, v46
    v_mul_f32 v46, v46, v44
    v_mul_f32 v46, v46, v47
    v_cmp_eq_f32 vcc, 1.0, v45
    s_nop 1
    v_cndmask_b32 v46, v46, v44, vcc
    v_cvt_pk_bf16_f32 v46, v46, v46
    v_lshlrev_b32 v46, 16, v46
    v_max_f32 v45, 0, v41
    v_add_f32 v46, v46, v45
    v_cvt_pk_bf16_f32 v46, v46, v46
    v_lshlrev_b32 v46, 16, v46
    v_mul_f32 v44, -2.0, v46
    v_mul_f32 v45, s32, v44
    v_exp_f32 v45, v45
    v_log_f32 v47, v45
    v_add_f32 v48, -1.0, v45
    v_mul_f32 v47, s33, v47
    v_rcp_f32 v47, v47
    v_mul_f32 v49, v48, v44
    v_mul_f32 v49, v49, v47
    v_cmp_eq_f32 vcc, 1.0, v45
    s_nop 1
    v_cndmask_b32 v49, v49, v44, vcc
    v_cmp_gt_f32 vcc, 0.5, v45
    s_nop 1
    v_cndmask_b32 v49, v49, v48, vcc
    v_add_f32 v48, 2.0, v49
    v_rcp_f32 v48, v48
    s_nop 0
    v_mul_f32 v49, v49, v48
    v_sub_f32 v49, 0, v49
    v_cvt_pk_bf16_f32 v49, v49, v49
    v_lshlrev_b32 v49, 16, v49
    v_mul_f32 v41, v41, v49
    v_cvt_pk_bf16_f32 v41, v41, v41
L_actw:
    v_lshlrev_b32 v11, 1, v11
    v_add_u32 v11, 121088, v11
    ds_write_b16 v11, v40
    ds_write_b16 v11, v41 offset:128
    s_mov_b64 exec, 1
    ds_write_b32 v20, v20 offset:32
    s_mov_b64 exec, -1
    s_waitcnt vmcnt(0)
    s_branch L_stchk
L_st6:
    buffer_load_dwordx2 v[120:121], v71, s[8:11], s78 offen sc1
    s_waitcnt vmcnt(0)
L_stchk:
    v_cmp_ne_u32 vcc, s5, v121
    s_cbranch_vccz L_ok7
    s_sleep 4
    s_add_u32 s101, s101, 1
    s_cmp_lt_u32 s101, 262144
    s_cbranch_scc1 L_st6
L_ok7:
    v_readfirstlane_b32 s34, v120
    s_nop 1
    v_subrev_u32 v120, s34, v120
    v_lshl_add_u32 v120, v120, 3, v70
    s_nop 1
    v_max_i32 v120, v120, v120 row_ror:1
    s_nop 1
    v_max_i32 v120, v120, v120 row_ror:2
    s_nop 1
    v_max_i32 v120, v120, v120 row_ror:4
    v_and_b32 v120, 7, v120
    s_mov_b64 exec, 1
    ds_write_b32 v20, v120 offset:28
    s_mov_b64 exec, -1
    v_lshrrev_b32 v16, 2, v0
    v_and_b32 v17, 3, v0
    v_lshlrev_b32 v21, 12, v16
    v_lshl_add_u32 v21, v17, 3, v21
    s_add_u32 s66, s65, 65536
    v_and_b32 v18, 15, v0
    v_lshlrev_b32 v18, 4, v18
    v_lshrrev_b32 v22, 4, v0
    v_lshl_add_u32 v22, v22, 2, v18
    v_add_u32 v22, 118016, v22
    s_movk_i32 s53, 0xff00
    s_mov_b32 s52, -2
L_wf8:
    ds_read_b32 v18, v20 offset:8
    s_waitcnt lgkmcnt(0)
    v_cmp_eq_u32 vcc, -1, v18
    s_cbranch_vccnz L_wf8
L_ml9:
    buffer_load_dwordx2 v[24:25], v21, s[8:11], s65 offen offset:3072 sc1
    buffer_load_dwordx2 v[26:27], v21, s[8:11], s66 offen offset:3072 sc1
    s_waitcnt vmcnt(0)
    v_mov_b32 v32, v24
    v_mov_b32 v33, v25
    v_mov_b32 v34, v26
    v_mov_b32 v35, v27
    v_bitop3_b32 v44, v32, v34, v156 bitop3:0x7e
    v_bitop3_b32 v45, v33, v35, v157 bitop3:0x7e
    v_or_b32 v44, v44, v45
    v_cmp_ne_u32_sdwa vcc, v44, v19 src0_sel:BYTE_0 src1_sel:DWORD
    s_cbranch_vccz L_ok10
    s_add_u32 s101, s101, 1
    s_cmp_lt_u32 s101, 262144
    s_cbranch_scc1 L_ml9
L_ok10:
    v_and_b32 v32, s53, v32
    v_and_b32 v34, s53, v34
    s_nop 0
    v_max_f32 v28, v32, v32 row_ror:4
    v_max_f32 v29, v34, v34 row_ror:4
    s_nop 0
    v_max_f32 v28, v28, v28 row_ror:8
    v_max_f32 v29, v29, v29 row_ror:8
    v_mov_b32 v30, v28
    v_mov_b32 v31, v29
    s_nop 0
    v_permlane32_swap_b32 v30, v28
    v_permlane32_swap_b32 v31, v29
    v_max_f32 v28, v28, v30
    v_max_f32 v29, v29, v31
    v_mov_b32 v30, v28
    v_mov_b32 v31, v29
    s_nop 0
    v_permlane16_swap_b32 v30, v28
    v_permlane16_swap_b32 v31, v29
    v_max_f32 v28, v28, v30
    v_max_f32 v29, v29, v31
    v_sub_f32 v32, v32, v28
    v_sub_f32 v34, v34, v29
    v_exp_f32 v32, v32
    v_exp_f32 v34, v34
    v_mul_f32 v33, v32, v33
    v_mul_f32 v35, v34, v35
    s_nop 0
    v_add_f32 v28, v33, v33 row_ror:4
    v_add_f32 v29, v35, v35 row_ror:4
    s_nop 0
    v_add_f32 v28, v28, v28 row_ror:8
    v_add_f32 v29, v29, v29 row_ror:8
    v_mov_b32 v30, v28
    v_mov_b32 v31, v29
    s_nop 0
    v_permlane32_swap_b32 v30, v28
    v_permlane32_swap_b32 v31, v29
    v_add_f32 v28, v28, v30
    v_add_f32 v29, v29, v31
    v_mov_b32 v30, v28
    v_mov_b32 v31, v29
    s_nop 0
    v_permlane16_swap_b32 v30, v28
    v_permlane16_swap_b32 v31, v29
    v_add_f32 v28, v28, v30
    v_add_f32 v29, v29, v31
    v_rcp_f32 v28, v28
    v_rcp_f32 v29, v29
    v_mul_f32 v32, v32, v28
    v_mul_f32 v34, v34, v29
    v_min_u32 v32, s52, v32
    v_min_u32 v34, s52, v34
    ds_write_b32 v22, v32
    ds_write_b32 v22, v34 offset:256
    s_waitcnt lgkmcnt(0)
    s_endpgm
L_compute:
    s_setprio 2
    s_sub_u32 s30, s3, 2
    v_lshlrev_b32 v2, 4, v0
    s_lshl_b32 s31, s30, 10
    s_add_u32 s31, s31, 114688
    v_add_u32 v3, s31, v2
    v_mov_b32 v4, -1
    v_mov_b32 v5, -1
    v_mov_b32 v6, -1
    v_mov_b32 v7, -1
    ds_write_b128 v3, v[4:7]
    s_mov_b32 s100, 0
    s_mov_b32 s101, 0
    s_waitcnt lgkmcnt(0)
    s_load_dword s54, s[26:27], 0
    s_barrier
    s_add_u32 s32, s26, 65536
    s_addc_u32 s33, s27, 0
    s_mov_b32 s34, 0x300000
    s_mov_b32 s35, 0x00020000
    s_mov_b32 s36, 0xffff0000
    v_and_b32 v4, 15, v0
    v_lshrrev_b32 v5, 4, v0
    v_mov_b32 v6, 117760
    v_bfe_u32 v96, v0, 2, 2
    v_and_b32 v17, 1, v5
    v_lshl_add_u32 v96, v17, 2, v96
    v_bfe_u32 v18, v0, 1, 1
    s_lshl_b32 s37, s30, 1
    v_add_u32 v18, s37, v18
    v_and_b32 v19, 6, v96
    v_xor_b32 v18, v18, v19
    v_lshlrev_b32 v18, 4, v18
    v_and_b32 v19, 1, v0
    v_lshl_add_u32 v18, v19, 3, v18
    v_lshrrev_b32 v17, 5, v0
    v_lshl_add_u32 v17, v17, 4, v96
    v_lshl_add_u32 v7, v17, 7, v18
    v_add_u32 v7, 65536, v7
    v_mul_u32_u24 v18, 1040, v19
    v_lshl_add_u32 v18, v5, 4, v18
    s_lshr_b32 s37, s29, 3
    s_lshl_b32 s37, s37, 8
    s_add_u32 s37, s37, 118784
    v_add_u32 v106, s37, v18
    s_lshl_b32 s37, s30, 6
    v_lshlrev_b32 v18, 8, v4
    v_lshl_add_u32 v18, v5, 4, v18
    v_add_u32 v107, s37, v18
    s_lshl_b32 s38, s28, 5
    s_add_u32 s38, s38, s29
    s_lshl_b32 s68, s38, 9
    s_lshl_b32 s38, s38, 12
    s_add_u32 s68, s68, 1048576
    v_add_u32 v3, 118784, v2
    v_add_u32 v16, 121344, v2
    s_mov_b32 s48, 0x00030003
    s_mov_b32 s49, 0x00030003
    s_mov_b32 s52, -2
    s_movk_i32 s53, 0xff00
L_wf11:
    ds_read_b32 v17, v6 offset:36
    s_waitcnt lgkmcnt(0)
    v_cmp_eq_u32 vcc, -1, v17
    s_cbranch_vccnz L_wf11
    ds_read_b128 v[8:11], v16
    ds_read_b128 v[12:15], v16 offset:1024
    s_add_u32 s54, s54, 1
    s_waitcnt lgkmcnt(0)
    v_lshlrev_b32 v16, 16, v8
    v_and_b32 v17, s36, v8
    v_lshlrev_b32 v18, 16, v9
    v_and_b32 v19, s36, v9
    v_lshlrev_b32 v20, 16, v10
    v_and_b32 v21, s36, v10
    v_lshlrev_b32 v22, 16, v11
    v_and_b32 v23, s36, v11
    v_lshlrev_b32 v24, 16, v12
    v_and_b32 v25, s36, v12
    v_lshlrev_b32 v26, 16, v13
    v_and_b32 v27, s36, v13
    v_lshlrev_b32 v28, 16, v14
    v_and_b32 v29, s36, v14
    v_lshlrev_b32 v30, 16, v15
    v_and_b32 v31, s36, v15
    v_pk_add_f32 v[32:33], v[16:17], v[18:19]
    v_pk_add_f32 v[34:35], v[20:21], v[22:23]
    v_pk_add_f32 v[36:37], v[24:25], v[26:27]
    v_pk_add_f32 v[38:39], v[28:29], v[30:31]
    v_pk_add_f32 v[32:33], v[32:33], v[34:35]
    v_pk_add_f32 v[36:37], v[36:37], v[38:39]
    v_add_f32 v32, v32, v33
    v_add_f32 v36, v36, v37
    s_nop 1
    v_permlane32_swap_b32 v32, v36
    v_add_f32 v32, v32, v36
    v_mov_b32 v33, v32
    s_nop 1
    v_permlane16_swap_b32 v33, v32
    v_add_f32 v32, v32, v33
    s_nop 1
    v_add_f32 v32, v32, v32 row_ror:8
    s_nop 1
    v_add_f32 v32, v32, v32 row_ror:4
    s_nop 1
    v_add_f32 v32, v32, v32 row_ror:2
    s_nop 1
    v_add_f32 v32, v32, v32 row_ror:1
    v_mul_f32 v32, 0x3b000000, v32
    s_nop 0
    v_readlane_b32 s60, v32, 0
    v_readlane_b32 s62, v32, 32
    s_nop 0
    v_pk_add_f32 v[40:41], v[16:17], s[60:61] op_sel_hi:[1,0] neg_lo:[0,1] neg_hi:[0,1]
    v_pk_add_f32 v[42:43], v[18:19], s[60:61] op_sel_hi:[1,0] neg_lo:[0,1] neg_hi:[0,1]
    v_pk_add_f32 v[44:45], v[20:21], s[60:61] op_sel_hi:[1,0] neg_lo:[0,1] neg_hi:[0,1]
    v_pk_add_f32 v[46:47], v[22:23], s[60:61] op_sel_hi:[1,0] neg_lo:[0,1] neg_hi:[0,1]
    v_pk_add_f32 v[48:49], v[24:25], s[62:63] op_sel_hi:[1,0] neg_lo:[0,1] neg_hi:[0,1]
    v_pk_add_f32 v[50:51], v[26:27], s[62:63] op_sel_hi:[1,0] neg_lo:[0,1] neg_hi:[0,1]
    v_pk_add_f32 v[52:53], v[28:29], s[62:63] op_sel_hi:[1,0] neg_lo:[0,1] neg_hi:[0,1]
    v_pk_add_f32 v[54:55], v[30:31], s[62:63] op_sel_hi:[1,0] neg_lo:[0,1] neg_hi:[0,1]
    v_pk_mul_f32 v[34:35], v[40:41], v[40:41]
    v_pk_mul_f32 v[36:37], v[48:49], v[48:49]
    v_pk_fma_f32 v[34:35], v[42:43], v[42:43], v[34:35]
    v_pk_fma_f32 v[36:37], v[50:51], v[50:51], v[36:37]
    v_pk_fma_f32 v[34:35], v[44:45], v[44:45], v[34:35]
    v_pk_fma_f32 v[36:37], v[52:53], v[52:53], v[36:37]
    v_pk_fma_f32 v[34:35], v[46:47], v[46:47], v[34:35]
    v_pk_fma_f32 v[36:37], v[54:55], v[54:55], v[36:37]
    v_add_f32 v34, v34, v35
    v_add_f32 v36, v36, v37
    s_nop 1
    v_permlane32_swap_b32 v34, v36
    v_add_f32 v34, v34, v36
    v_mov_b32 v33, v34
    s_nop 1
    v_permlane16_swap_b32 v33, v34
    v_add_f32 v34, v34, v33
    s_nop 1
    v_add_f32 v34, v34, v34 row_ror:8
    s_nop 1
    v_add_f32 v34, v34, v34 row_ror:4
    s_nop 1
    v_add_f32 v34, v34, v34 row_ror:2
    s_nop 1
    v_add_f32 v34, v34, v34 row_ror:1
    v_mul_f32 v34, 0x3b000000, v34
    v_cvt_pk_bf16_f32 v34, v34, v34
    v_lshlrev_b32 v34, 16, v34
    v_add_f32 v34, 0x3727c5ac, v34
    v_cvt_pk_bf16_f32 v34, v34, v34
    v_lshlrev_b32 v34, 16, v34
    v_sqrt_f32 v34, v34
    v_cvt_pk_bf16_f32 v32, v32, v32
    v_lshlrev_b32 v32, 16, v32
    v_cvt_pk_bf16_f32 v34, v34, v34
    v_lshlrev_b32 v34, 16, v34
    v_rcp_f32 v34, v34
    v_readlane_b32 s60, v32, 0
    v_readlane_b32 s62, v32, 32
    v_readlane_b32 s64, v34, 0
    v_readlane_b32 s66, v34, 32
    v_pk_add_f32 v[16:17], v[16:17], s[60:61] op_sel_hi:[1,0] neg_lo:[0,1] neg_hi:[0,1]
    v_pk_add_f32 v[18:19], v[18:19], s[60:61] op_sel_hi:[1,0] neg_lo:[0,1] neg_hi:[0,1]
    v_pk_add_f32 v[20:21], v[20:21], s[60:61] op_sel_hi:[1,0] neg_lo:[0,1] neg_hi:[0,1]
    v_pk_add_f32 v[22:23], v[22:23], s[60:61] op_sel_hi:[1,0] neg_lo:[0,1] neg_hi:[0,1]
    v_pk_add_f32 v[24:25], v[24:25], s[62:63] op_sel_hi:[1,0] neg_lo:[0,1] neg_hi:[0,1]
    v_pk_add_f32 v[26:27], v[26:27], s[62:63] op_sel_hi:[1,0] neg_lo:[0,1] neg_hi:[0,1]
    v_pk_add_f32 v[28:29], v[28:29], s[62:63] op_sel_hi:[1,0] neg_lo:[0,1] neg_hi:[0,1]
    v_pk_add_f32 v[30:31], v[30:31], s[62:63] op_sel_hi:[1,0] neg_lo:[0,1] neg_hi:[0,1]
    v_cvt_pk_bf16_f32 v8, v16, v17
    v_cvt_pk_bf16_f32 v9, v18, v19
    v_cvt_pk_bf16_f32 v10, v20, v21
    v_cvt_pk_bf16_f32 v11, v22, v23
    v_cvt_pk_bf16_f32 v12, v24, v25
    v_cvt_pk_bf16_f32 v13, v26, v27
    v_cvt_pk_bf16_f32 v14, v28, v29
    v_cvt_pk_bf16_f32 v15, v30, v31
    v_lshlrev_b32 v16, 16, v8
    v_and_b32 v17, s36, v8
    v_lshlrev_b32 v18, 16, v9
    v_and_b32 v19, s36, v9
    v_lshlrev_b32 v20, 16, v10
    v_and_b32 v21, s36, v10
    v_lshlrev_b32 v22, 16, v11
    v_and_b32 v23, s36, v11
    v_lshlrev_b32 v24, 16, v12
    v_and_b32 v25, s36, v12
    v_lshlrev_b32 v26, 16, v13
    v_and_b32 v27, s36, v13
    v_lshlrev_b32 v28, 16, v14
    v_and_b32 v29, s36, v14
    v_lshlrev_b32 v30, 16, v15
    v_and_b32 v31, s36, v15
    v_pk_mul_f32 v[16:17], v[16:17], s[64:65] op_sel_hi:[1,0]
    v_pk_mul_f32 v[18:19], v[18:19], s[64:65] op_sel_hi:[1,0]
    v_pk_mul_f32 v[20:21], v[20:21], s[64:65] op_sel_hi:[1,0]
    v_pk_mul_f32 v[22:23], v[22:23], s[64:65] op_sel_hi:[1,0]
    v_pk_mul_f32 v[24:25], v[24:25], s[66:67] op_sel_hi:[1,0]
    v_pk_mul_f32 v[26:27], v[26:27], s[66:67] op_sel_hi:[1,0]
    v_pk_mul_f32 v[28:29], v[28:29], s[66:67] op_sel_hi:[1,0]
    v_pk_mul_f32 v[30:31], v[30:31], s[66:67] op_sel_hi:[1,0]
    v_cvt_pk_bf16_f32 v8, v16, v17
    v_cvt_pk_bf16_f32 v9, v18, v19
    v_cvt_pk_bf16_f32 v10, v20, v21
    v_cvt_pk_bf16_f32 v11, v22, v23
    v_cvt_pk_bf16_f32 v12, v24, v25
    v_cvt_pk_bf16_f32 v13, v26, v27
    v_cvt_pk_bf16_f32 v14, v28, v29
    v_cvt_pk_bf16_f32 v15, v30, v31
    ds_write_b128 v3, v[8:11]
    ds_write_b128 v3, v[12:15] offset:1040
    s_mov_b64 exec, 1
    ds_write_b32 v6, v6 offset:56
    s_mov_b64 exec, -1
    s_mov_b32 s72, s54
    s_lshr_b32 s73, s54, 8
    s_lshr_b32 s74, s54, 16
    s_lshr_b32 s75, s54, 24
    v_mov_b32 v156, 0xff
    v_and_b32 v152, s72, v156
    v_and_b32 v153, s73, v156
    v_and_b32 v154, s74, v156
    v_and_b32 v155, s75, v156
    v_and_b32 v157, 1, v0
    v_cmp_eq_u32 vcc, 0, v157
    s_nop 1
    v_cndmask_b32 v156, v154, v152, vcc
    v_cndmask_b32 v157, v155, v153, vcc
    s_waitcnt lgkmcnt(0)
    ds_read_b128 v[24:27], v106 offset:0
    ds_read_b128 v[28:31], v106 offset:64
    ds_read_b128 v[32:35], v106 offset:128
    ds_read_b128 v[36:39], v106 offset:192
L_wf12:
    ds_read_b32 v16, v6 offset:0
    s_waitcnt lgkmcnt(0)
    v_cmp_eq_u32 vcc, -1, v16
    s_cbranch_vccnz L_wf12
    ds_read_b64_tr_b16 v[48:49], v7 offset:0
    ds_read_b64_tr_b16 v[50:51], v7 offset:1024
    ds_read_b64_tr_b16 v[52:53], v7 offset:4096
    ds_read_b64_tr_b16 v[54:55], v7 offset:5120
    ds_read_b64_tr_b16 v[56:57], v7 offset:8192
    ds_read_b64_tr_b16 v[58:59], v7 offset:9216
    ds_read_b64_tr_b16 v[60:61], v7 offset:12288
    ds_read_b64_tr_b16 v[62:63], v7 offset:13312
    s_waitcnt lgkmcnt(6)
    v_mfma_f32_16x16x32_bf16 v[88:91], v[48:51], v[24:27], 0
    s_waitcnt lgkmcnt(4)
    v_mfma_f32_16x16x32_bf16 v[88:91], v[52:55], v[28:31], v[88:91]
    s_waitcnt lgkmcnt(2)
    v_mfma_f32_16x16x32_bf16 v[88:91], v[56:59], v[32:35], v[88:91]
    s_waitcnt lgkmcnt(0)
    v_mfma_f32_16x16x32_bf16 v[88:91], v[60:63], v[36:39], v[88:91]
    s_nop 7
    v_and_or_b32 v88, v88, s53, v152
    v_and_or_b32 v89, v89, s53, v153
    v_and_or_b32 v90, v90, s53, v154
    v_and_or_b32 v91, v91, s53, v155
    s_mov_b64 exec, s[48:49]
    buffer_store_dwordx4 v[88:91], v107, s[32:35], s38 offen offset:0
    s_mov_b64 exec, -1
    v_lshlrev_b32 v119, 15, v5
    v_lshl_add_u32 v119, v4, 4, v119
    s_lshl_b32 s39, s28, 17
    s_lshl_b32 s37, s30, 13
    s_add_u32 s39, s39, s37
    s_lshr_b32 s37, s29, 4
    s_lshl_b32 s37, s37, 8
    s_add_u32 s39, s39, s37
    s_add_u32 s40, s39, 4096
    v_lshlrev_b32 v118, 5, v5
    v_lshl_add_u32 v118, v4, 4, v118
    s_lshl_b32 s37, s30, 7
    v_add_u32 v118, s37, v118
    v_mov_b32 v123, 0
    v_and_b32 v19, 1, v0
    v_bfe_u32 v18, v0, 1, 1
    s_lshl_b32 s37, s30, 2
    v_add_u32 v18, s37, v18
    v_lshlrev_b32 v17, 1, v96
    v_xor_b32 v18, v18, v17
    v_lshlrev_b32 v18, 4, v18
    v_lshl_add_u32 v18, v19, 3, v18
    v_lshrrev_b32 v17, 2, v0
    v_lshl_add_u32 v100, v17, 8, v18
    s_lshl_b32 s37, s30, 2
    v_add_u32 v101, s37, v6
    v_and_b32 v17, 7, v0
    v_lshlrev_b32 v17, 1, v17
    v_xor_b32 v17, v17, v5
    v_lshlrev_b32 v17, 4, v17
    v_lshl_add_u32 v17, v4, 8, v17
    s_lshl_b32 s37, s30, 13
    v_add_u32 v102, s37, v17
    v_xor_b32 v103, 64, v102
    v_xor_b32 v104, 128, v102
    v_xor_b32 v105, 192, v102
    v_mul_u32_u24 v116, 272, v19
    v_lshl_add_u32 v116, v5, 4, v116
    v_add_u32 v116, 116992, v116
    v_lshlrev_b32 v117, 7, v19
    v_lshl_add_u32 v117, v5, 4, v117
    v_add_u32 v117, 121088, v117
    v_lshrrev_b32 v17, 5, v0
    v_lshlrev_b32 v17, 7, v17
    v_lshl_add_u32 v17, v4, 3, v17
    v_and_b32 v18, 1, v5
    v_lshl_add_u32 v17, v18, 2, v17
    s_mul_i32 s37, s30, 272
    s_add_u32 s37, s37, 114688
    v_add_u32 v120, s37, v17
    v_and_b32 v19, 3, v0
    v_mul_u32_u24 v121, 272, v19
    v_lshl_add_u32 v121, v5, 4, v121
    v_add_u32 v121, 114688, v121
    v_lshlrev_b32 v20, 6, v5
    v_lshl_add_u32 v20, v19, 4, v20
    v_add_u32 v108, 115968, v20
    s_lshl_b32 s37, s30, 8
    v_add_u32 v110, s37, v108
    s_lshl_b32 s37, s30, 9
    v_add_u32 v109, s37, v20
    s_and_b32 s41, s30, 1
    s_lshl_b32 s37, s41, 8
    s_add_u32 s37, s37, 118016
    v_add_u32 v114, s37, v20
    v_lshlrev_b32 v111, 5, v19
    v_add_u32 v111, 117568, v111
    s_lshl_b32 s37, s30, 2
    v_add_u32 v112, s37, v111
    v_lshlrev_b32 v106, 3, v4
    v_lshlrev_b32 v16, 12, v5
    v_lshl_add_u32 v113, v4, 4, v16
    s_and_b32 s43, s29, 3
    s_lshl_b32 s37, s43, 9
    s_lshr_b32 s42, s30, 1
    s_lshl_b32 s44, s42, 8
    s_add_u32 s37, s37, s44
    v_add_u32 v113, s37, v113
    s_lshl_b32 s44, s28, 17
    s_lshl_b32 s37, s41, 16
    s_add_u32 s44, s44, s37
    s_add_u32 s45, s44, 16384
    s_add_u32 s46, s44, 32768
    s_add_u32 s47, s44, 49152
    v_lshlrev_b32 v115, 4, v4
    v_lshl_add_u32 v115, v18, 2, v115
    s_mul_i32 s37, s41, 272
    s_lshl_b32 s42, s42, 3
    s_add_u32 s37, s37, s42
    s_add_u32 s37, s37, 116992
    v_add_u32 v115, s37, v115
    s_mov_b32 s50, 0x000f000f
    s_mov_b32 s51, 0x000f000f
    s_mov_b32 s58, 0x3db504f3
    s_mov_b32 s59, 0x3fb8aa3b
    s_lshl_b32 s70, s29, 9
    s_lshl_b32 s37, s30, 7
    s_add_u32 s70, s70, s37
    s_add_u32 s70, s70, 1048576
    v_lshrrev_b32 v17, 3, v0
    v_lshlrev_b32 v17, 14, v17
    v_and_b32 v16, 7, v0
    v_lshl_add_u32 v99, v16, 4, v17
    v_and_b32 v16, 1, v0
    v_lshlrev_b32 v16, 10, v16
    v_bfe_u32 v17, v0, 1, 2
    v_lshl_add_u32 v16, v17, 3, v16
    v_lshrrev_b32 v17, 5, v0
    v_lshl_add_u32 v16, v17, 2, v16
    s_lshr_b32 s37, s29, 2
    s_lshl_b32 s37, s37, 7
    s_lshl_b32 s41, s30, 5
    s_add_u32 s37, s37, s41
    v_add_u32 v98, s37, v16
    v_add_u32 v17, 121344, v98
    ds_read_b32 v97, v17
    s_lshl_b32 s79, s43, 3
    s_add_u32 s79, s79, s28
    s_add_u32 s37, s43, 0
    s_and_b32 s37, s37, 3
    s_lshl_b32 s41, s37, 13
    v_add_u32 v80, s41, v100
    s_lshl_b32 s41, s37, 8
    v_add_u32 v76, s41, v108
    v_xor_b32 v81, 32, v80
    s_add_u32 s37, s43, 1
    s_and_b32 s37, s37, 3
    s_lshl_b32 s41, s37, 13
    v_add_u32 v82, s41, v100
    s_lshl_b32 s41, s37, 8
    v_add_u32 v77, s41, v108
    v_xor_b32 v83, 32, v82
    s_add_u32 s37, s43, 2
    s_and_b32 s37, s37, 3
    s_lshl_b32 s41, s37, 13
    v_add_u32 v84, s41, v100
    s_lshl_b32 s41, s37, 8
    v_add_u32 v78, s41, v108
    v_xor_b32 v85, 32, v84
    s_add_u32 s37, s43, 3
    s_and_b32 s37, s37, 3
    s_lshl_b32 s41, s37, 13
    v_add_u32 v86, s41, v100
    s_lshl_b32 s41, s37, 8
    v_add_u32 v79, s41, v108
    v_xor_b32 v87, 32, v86
    s_mov_b64 exec, s[48:49]
    buffer_load_dword v124, v118, s[32:35], s68 offen
    s_mov_b64 exec, -1
    s_mov_b32 s56, 0
    s_sleep 4
    buffer_load_dwordx4 v[128:131], v119, s[32:35], s39 offen offset:0 sc1
    buffer_load_dwordx4 v[132:135], v119, s[32:35], s40 offen offset:0 sc1
    s_sleep 12
    buffer_load_dwordx4 v[136:139], v119, s[32:35], s39 offen offset:0 sc1
    buffer_load_dwordx4 v[140:143], v119, s[32:35], s40 offen offset:0 sc1
    s_sleep 12
    buffer_load_dwordx4 v[144:147], v119, s[32:35], s39 offen offset:0 sc1
    buffer_load_dwordx4 v[148:151], v119, s[32:35], s40 offen offset:0 sc1
L_wf13:
    ds_read_b32 v41, v6 offset:8
    s_waitcnt lgkmcnt(0)
    v_cmp_eq_u32 vcc, -1, v41
    s_cbranch_vccnz L_wf13
    ds_read_b128 v[44:47], v102 offset:0
    ds_read_b128 v[48:51], v103 offset:0
    ds_read_b128 v[52:55], v104 offset:0
    ds_read_b128 v[56:59], v105 offset:0
    ds_read_b128 v[60:63], v102 offset:4096
    ds_read_b128 v[64:67], v103 offset:4096
    ds_read_b128 v[68:71], v104 offset:4096
    ds_read_b128 v[72:75], v105 offset:4096
L_qp:
    s_waitcnt vmcnt(4)
    v_bitop3_b32 v40, v128, v132, s72 bitop3:0x7e
    v_bitop3_b32 v41, v129, v133, s73 bitop3:0x7e
    v_bitop3_b32 v42, v130, v134, s74 bitop3:0x7e
    v_bitop3_b32 v43, v131, v135, s75 bitop3:0x7e
    v_or3_b32 v40, v40, v41, v42
    v_or_b32 v43, v43, v40
    v_cmp_ne_u32_sdwa vcc, v43, v123 src0_sel:BYTE_0 src1_sel:DWORD
    s_cbranch_vccz L_qok0
    buffer_load_dwordx4 v[128:131], v119, s[32:35], s39 offen offset:0 sc1
    buffer_load_dwordx4 v[132:135], v119, s[32:35], s40 offen offset:0 sc1
    s_waitcnt vmcnt(4)
    v_bitop3_b32 v40, v136, v140, s72 bitop3:0x7e
    v_bitop3_b32 v41, v137, v141, s73 bitop3:0x7e
    v_bitop3_b32 v42, v138, v142, s74 bitop3:0x7e
    v_bitop3_b32 v43, v139, v143, s75 bitop3:0x7e
    v_or3_b32 v40, v40, v41, v42
    v_or_b32 v43, v43, v40
    v_cmp_ne_u32_sdwa vcc, v43, v123 src0_sel:BYTE_0 src1_sel:DWORD
    s_cbranch_vccz L_qok1
    buffer_load_dwordx4 v[136:139], v119, s[32:35], s39 offen offset:0 sc1
    buffer_load_dwordx4 v[140:143], v119, s[32:35], s40 offen offset:0 sc1
    s_waitcnt vmcnt(4)
    v_bitop3_b32 v40, v144, v148, s72 bitop3:0x7e
    v_bitop3_b32 v41, v145, v149, s73 bitop3:0x7e
    v_bitop3_b32 v42, v146, v150, s74 bitop3:0x7e
    v_bitop3_b32 v43, v147, v151, s75 bitop3:0x7e
    v_or3_b32 v40, v40, v41, v42
    v_or_b32 v43, v43, v40
    v_cmp_ne_u32_sdwa vcc, v43, v123 src0_sel:BYTE_0 src1_sel:DWORD
    s_cbranch_vccz L_qok2
    buffer_load_dwordx4 v[144:147], v119, s[32:35], s39 offen offset:0 sc1
    buffer_load_dwordx4 v[148:151], v119, s[32:35], s40 offen offset:0 sc1
    ds_read_b32 v40, v6 offset:40
    s_waitcnt lgkmcnt(0)
    v_readfirstlane_b32 s57, v40
    s_xor_b32 s57, s57, 1
    s_or_b32 s57, s57, s56
    s_cbranch_scc1 L_norep
    s_xor_b32 s37, s38, 2097152
    s_mov_b64 exec, s[48:49]
    buffer_store_dwordx4 v[88:91], v107, s[32:35], s37 offen offset:0 sc1
    s_mov_b64 exec, -1
    s_mov_b32 s56, 1
    s_waitcnt vmcnt(0)
    buffer_load_dwordx4 v[128:131], v119, s[32:35], s39 offen offset:0 sc1
    buffer_load_dwordx4 v[132:135], v119, s[32:35], s40 offen offset:0 sc1
    buffer_load_dwordx4 v[136:139], v119, s[32:35], s39 offen offset:0 sc1
    buffer_load_dwordx4 v[140:143], v119, s[32:35], s40 offen offset:0 sc1
    buffer_load_dwordx4 v[144:147], v119, s[32:35], s39 offen offset:0 sc1
    buffer_load_dwordx4 v[148:151], v119, s[32:35], s40 offen offset:0 sc1
L_norep:
    s_lshl_b32 s37, s56, 21
    s_xor_b32 s39, s39, s37
    s_xor_b32 s40, s40, s37
    s_add_u32 s101, s101, 1
    s_cmp_lt_u32 s101, 262144
    s_cbranch_scc1 L_qp
L_qok2:
    v_permlane32_swap_b32 v144, v148
    v_permlane32_swap_b32 v145, v149
    v_permlane32_swap_b32 v146, v150
    v_permlane32_swap_b32 v147, v151
    v_pk_add_f32 v[40:41], v[144:145], v[148:149]
    v_pk_add_f32 v[42:43], v[146:147], v[150:151]
    s_branch L_qj
L_qok1:
    v_permlane32_swap_b32 v136, v140
    v_permlane32_swap_b32 v137, v141
    v_permlane32_swap_b32 v138, v142
    v_permlane32_swap_b32 v139, v143
    v_pk_add_f32 v[40:41], v[136:137], v[140:141]
    v_pk_add_f32 v[42:43], v[138:139], v[142:143]
    s_branch L_qj
L_qok0:
    v_permlane32_swap_b32 v128, v132
    v_permlane32_swap_b32 v129, v133
    v_permlane32_swap_b32 v130, v134
    v_permlane32_swap_b32 v131, v135
    v_pk_add_f32 v[40:41], v[128:129], v[132:133]
    v_pk_add_f32 v[42:43], v[130:131], v[134:135]
L_qj:
    s_nop 1
    v_permlane16_swap_b32 v40, v42
    v_permlane16_swap_b32 v41, v43
    v_pk_add_f32 v[40:41], v[40:41], v[42:43]
    v_cvt_pk_bf16_f32 v40, v40, v41
    v_min_u32 v40, s52, v40
    ds_write_b32 v120, v40
L_ql14:
    ds_read_b128 v[16:19], v121 offset:0
    ds_read_b128 v[20:23], v121 offset:64
    ds_read_b128 v[24:27], v121 offset:128
    ds_read_b128 v[28:31], v121 offset:192
    s_waitcnt lgkmcnt(0)
    v_max3_u32 v40, v16, v17, v18
    v_max3_u32 v40, v40, v19, v20
    v_max3_u32 v40, v40, v21, v22
    v_max3_u32 v40, v40, v23, v24
    v_max3_u32 v40, v40, v25, v26
    v_max3_u32 v40, v40, v27, v28
    v_max3_u32 v40, v40, v29, v30
    v_max3_u32 v40, v40, v31, v31
    v_cmp_eq_u32 vcc, -1, v40
    s_cbranch_vccnz L_ql14
    v_mfma_f32_16x16x32_bf16 v[8:11], v[44:47], v[16:19], 0
    v_mfma_f32_16x16x32_bf16 v[12:15], v[60:63], v[16:19], 0
    v_mfma_f32_16x16x32_bf16 v[8:11], v[48:51], v[20:23], v[8:11]
    v_mfma_f32_16x16x32_bf16 v[12:15], v[64:67], v[20:23], v[12:15]
    v_mfma_f32_16x16x32_bf16 v[8:11], v[52:55], v[24:27], v[8:11]
    v_mfma_f32_16x16x32_bf16 v[12:15], v[68:71], v[24:27], v[12:15]
    v_mfma_f32_16x16x32_bf16 v[8:11], v[56:59], v[28:31], v[8:11]
    v_mfma_f32_16x16x32_bf16 v[12:15], v[72:75], v[28:31], v[12:15]
    ds_read_b32 v42, v6 offset:40
    s_nop 5
    v_cvt_pk_bf16_f32 v24, v8, v9
    v_cvt_pk_bf16_f32 v25, v10, v11
    v_cvt_pk_bf16_f32 v26, v12, v13
    v_cvt_pk_bf16_f32 v27, v14, v15
    v_lshlrev_b32 v8, 16, v24
    v_and_b32 v9, s36, v24
    v_lshlrev_b32 v10, 16, v25
    v_and_b32 v11, s36, v25
    v_lshlrev_b32 v12, 16, v26
    v_and_b32 v13, s36, v26
    v_lshlrev_b32 v14, 16, v27
    v_and_b32 v15, s36, v27
    v_pk_mul_f32 v[8:9], v[8:9], s[58:59] op_sel_hi:[1,0]
    v_pk_mul_f32 v[10:11], v[10:11], s[58:59] op_sel_hi:[1,0]
    v_pk_mul_f32 v[12:13], v[12:13], s[58:59] op_sel_hi:[1,0]
    v_pk_mul_f32 v[14:15], v[14:15], s[58:59] op_sel_hi:[1,0]
    v_cvt_pk_bf16_f32 v24, v8, v9
    v_cvt_pk_bf16_f32 v25, v10, v11
    v_cvt_pk_bf16_f32 v26, v12, v13
    v_cvt_pk_bf16_f32 v27, v14, v15
    v_lshlrev_b32 v8, 16, v24
    v_and_b32 v9, s36, v24
    v_lshlrev_b32 v10, 16, v25
    v_and_b32 v11, s36, v25
    v_lshlrev_b32 v12, 16, v26
    v_and_b32 v13, s36, v26
    v_lshlrev_b32 v14, 16, v27
    v_and_b32 v15, s36, v27
    v_max3_f32 v24, v8, v9, v10
    v_max3_f32 v25, v11, v12, v13
    v_max3_f32 v24, v24, v14, v15
    v_max_f32 v24, v24, v25
    v_mov_b32 v25, v24
    s_nop 1
    v_permlane32_swap_b32 v25, v24
    v_max_f32 v24, v24, v25
    v_mov_b32 v25, v24
    s_nop 1
    v_permlane16_swap_b32 v25, v24
    v_max_f32 v24, v24, v25
    v_min_u32 v25, s52, v24
    s_mov_b64 exec, 15
    ds_write_b32 v112, v25
    s_mov_b64 exec, -1
L_ml15:
    ds_read_b128 v[28:31], v111
    s_waitcnt lgkmcnt(0)
    v_max3_u32 v20, v28, v29, v30
    v_max3_u32 v20, v20, v31, v31
    v_cmp_eq_u32 vcc, -1, v20
    s_cbranch_vccnz L_ml15
    v_max3_f32 v26, v28, v29, v30
    v_max_f32 v26, v26, v31
    v_mul_f32 v26, s59, v26
    v_and_b32 v26, s53, v26
    v_fma_f32 v8, v8, s59, -v26
    v_fma_f32 v9, v9, s59, -v26
    v_fma_f32 v10, v10, s59, -v26
    v_fma_f32 v11, v11, s59, -v26
    v_fma_f32 v12, v12, s59, -v26
    v_fma_f32 v13, v13, s59, -v26
    v_fma_f32 v14, v14, s59, -v26
    v_fma_f32 v15, v15, s59, -v26
    v_exp_f32 v8, v8
    v_exp_f32 v9, v9
    v_exp_f32 v10, v10
    v_exp_f32 v11, v11
    v_exp_f32 v12, v12
    v_exp_f32 v13, v13
    v_exp_f32 v14, v14
    v_exp_f32 v15, v15
    v_cvt_pk_bf16_f32 v16, v8, v9
    v_cvt_pk_bf16_f32 v17, v10, v11
    v_cvt_pk_bf16_f32 v18, v12, v13
    v_cvt_pk_bf16_f32 v19, v14, v15
    v_min_u32 v16, s52, v16
    v_min_u32 v17, s52, v17
    v_min_u32 v18, s52, v18
    v_min_u32 v19, s52, v19
    s_mov_b64 exec, s[50:51]
    ds_write_b128 v110, v[16:19]
    s_mov_b64 exec, -1
    v_pk_add_f32 v[28:29], v[8:9], v[10:11]
    v_pk_add_f32 v[30:31], v[12:13], v[14:15]
    v_pk_add_f32 v[28:29], v[28:29], v[30:31]
    v_add_f32 v25, v28, v29
    v_mov_b32 v27, v25
    s_nop 1
    v_permlane32_swap_b32 v27, v25
    v_add_f32 v25, v25, v27
    v_mov_b32 v27, v25
    s_nop 1
    v_permlane16_swap_b32 v27, v25
    v_add_f32 v25, v25, v27
    v_min_u32 v25, s52, v25
    s_mov_b64 exec, 15
    ds_write_b32 v112, v25 offset:16
    s_mov_b64 exec, -1
    v_readfirstlane_b32 s57, v42
    s_cmp_eq_u32 s57, 0
    s_cbranch_scc1 L_modeok
L_wf16:
    ds_read_b32 v42, v6 offset:40
    s_waitcnt lgkmcnt(0)
    v_cmp_eq_u32 vcc, -1, v42
    s_cbranch_vccnz L_wf16
    v_readfirstlane_b32 s57, v42
    s_xor_b32 s37, s57, 1
    s_or_b32 s37, s37, s56
    s_cbranch_scc1 L_modeok
    s_xor_b32 s37, s38, 2097152
    s_mov_b64 exec, s[48:49]
    buffer_store_dwordx4 v[88:91], v107, s[32:35], s37 offen offset:0 sc1
    s_mov_b64 exec, -1
    s_mov_b32 s56, 1
L_modeok:
    s_cmp_eq_u32 s30, 0
    s_cbranch_scc0 L_noml
L_ll17:
    ds_read_b128 v[28:31], v111 offset:16
    s_waitcnt lgkmcnt(0)
    v_max3_u32 v20, v28, v29, v30
    v_max3_u32 v20, v20, v31, v31
    v_cmp_eq_u32 vcc, -1, v20
    s_cbranch_vccnz L_ll17
    v_pk_add_f32 v[28:29], v[28:29], v[30:31]
    v_or_b32 v26, v26, v156
    v_add_f32 v27, v28, v29
    v_and_or_b32 v27, v27, s53, v157
    s_mov_b64 exec, 65535
    s_cmp_eq_u32 s57, 0
    s_cbranch_scc1 L_mlf
    buffer_store_dwordx2 v[26:27], v106, s[32:35], s38 offen offset:3072 sc1
    s_branch L_mle
L_mlf:
    buffer_store_dwordx2 v[26:27], v106, s[32:35], s38 offen offset:3072
L_mle:
    s_mov_b64 exec, -1
L_noml:
L_pl18:
    ds_read_b128 v[44:47], v76
    ds_read_b128 v[48:51], v77
    ds_read_b128 v[52:55], v78
    ds_read_b128 v[56:59], v79
    s_waitcnt lgkmcnt(0)
    v_max3_u32 v20, v44, v45, v46
    v_max3_u32 v20, v20, v47, v48
    v_max3_u32 v20, v20, v49, v50
    v_max3_u32 v20, v20, v51, v52
    v_max3_u32 v20, v20, v53, v54
    v_max3_u32 v20, v20, v55, v56
    v_max3_u32 v20, v20, v57, v58
    v_max3_u32 v20, v20, v59, v59
    v_cmp_eq_u32 vcc, -1, v20
    s_cbranch_vccnz L_pl18
    ds_read_b32 v20, v6 offset:12
    s_waitcnt lgkmcnt(0)
    v_cmp_eq_u32 vcc, -1, v20
    s_cbranch_vccz L_pvall
L_wf19:
    ds_read_b32 v20, v6 offset:44
    s_waitcnt lgkmcnt(0)
    v_cmp_eq_u32 vcc, -1, v20
    s_cbranch_vccnz L_wf19
    ds_read_b64_tr_b16 v[24:25], v80 offset:32768
    ds_read_b64_tr_b16 v[26:27], v80 offset:36864
    ds_read_b64_tr_b16 v[28:29], v81 offset:32768
    ds_read_b64_tr_b16 v[30:31], v81 offset:36864
    s_waitcnt lgkmcnt(0)
    v_mfma_f32_16x16x32_bf16 v[12:15], v[24:27], v[44:47], 0
    v_mfma_f32_16x16x32_bf16 v[16:19], v[28:31], v[44:47], 0
L_wf20:
    ds_read_b32 v20, v6 offset:48
    s_waitcnt lgkmcnt(0)
    v_cmp_eq_u32 vcc, -1, v20
    s_cbranch_vccnz L_wf20
    ds_read_b64_tr_b16 v[32:33], v82 offset:32768
    ds_read_b64_tr_b16 v[34:35], v82 offset:36864
    ds_read_b64_tr_b16 v[36:37], v83 offset:32768
    ds_read_b64_tr_b16 v[38:39], v83 offset:36864
    s_waitcnt lgkmcnt(0)
    v_mfma_f32_16x16x32_bf16 v[12:15], v[32:35], v[48:51], v[12:15]
    v_mfma_f32_16x16x32_bf16 v[16:19], v[36:39], v[48:51], v[16:19]
L_wf21:
    ds_read_b32 v20, v6 offset:52
    s_waitcnt lgkmcnt(0)
    v_cmp_eq_u32 vcc, -1, v20
    s_cbranch_vccnz L_wf21
    ds_read_b64_tr_b16 v[24:25], v84 offset:32768
    ds_read_b64_tr_b16 v[26:27], v84 offset:36864
    ds_read_b64_tr_b16 v[28:29], v85 offset:32768
    ds_read_b64_tr_b16 v[30:31], v85 offset:36864
    s_waitcnt lgkmcnt(0)
    v_mfma_f32_16x16x32_bf16 v[12:15], v[24:27], v[52:55], v[12:15]
    v_mfma_f32_16x16x32_bf16 v[16:19], v[28:31], v[52:55], v[16:19]
L_wf22:
    ds_read_b32 v20, v6 offset:12
    s_waitcnt lgkmcnt(0)
    v_cmp_eq_u32 vcc, -1, v20
    s_cbranch_vccnz L_wf22
    ds_read_b64_tr_b16 v[32:33], v86 offset:32768
    ds_read_b64_tr_b16 v[34:35], v86 offset:36864
    ds_read_b64_tr_b16 v[36:37], v87 offset:32768
    ds_read_b64_tr_b16 v[38:39], v87 offset:36864
    s_waitcnt lgkmcnt(0)
    v_mfma_f32_16x16x32_bf16 v[12:15], v[32:35], v[56:59], v[12:15]
    v_mfma_f32_16x16x32_bf16 v[16:19], v[36:39], v[56:59], v[16:19]
    s_branch L_pvdone
L_pvall:
    ds_read_b64_tr_b16 v[24:25], v80 offset:32768
    ds_read_b64_tr_b16 v[26:27], v80 offset:36864
    ds_read_b64_tr_b16 v[28:29], v81 offset:32768
    ds_read_b64_tr_b16 v[30:31], v81 offset:36864
    ds_read_b64_tr_b16 v[32:33], v82 offset:32768
    ds_read_b64_tr_b16 v[34:35], v82 offset:36864
    ds_read_b64_tr_b16 v[36:37], v83 offset:32768
    ds_read_b64_tr_b16 v[38:39], v83 offset:36864
    s_waitcnt lgkmcnt(4)
    v_mfma_f32_16x16x32_bf16 v[12:15], v[24:27], v[44:47], 0
    v_mfma_f32_16x16x32_bf16 v[16:19], v[28:31], v[44:47], 0
    ds_read_b64_tr_b16 v[24:25], v84 offset:32768
    ds_read_b64_tr_b16 v[26:27], v84 offset:36864
    ds_read_b64_tr_b16 v[28:29], v85 offset:32768
    ds_read_b64_tr_b16 v[30:31], v85 offset:36864
    s_waitcnt lgkmcnt(4)
    v_mfma_f32_16x16x32_bf16 v[12:15], v[32:35], v[48:51], v[12:15]
    v_mfma_f32_16x16x32_bf16 v[16:19], v[36:39], v[48:51], v[16:19]
    ds_read_b64_tr_b16 v[32:33], v86 offset:32768
    ds_read_b64_tr_b16 v[34:35], v86 offset:36864
    ds_read_b64_tr_b16 v[36:37], v87 offset:32768
    ds_read_b64_tr_b16 v[38:39], v87 offset:36864
    s_waitcnt lgkmcnt(4)
    v_mfma_f32_16x16x32_bf16 v[12:15], v[24:27], v[52:55], v[12:15]
    v_mfma_f32_16x16x32_bf16 v[16:19], v[28:31], v[52:55], v[16:19]
    s_waitcnt lgkmcnt(0)
    v_mfma_f32_16x16x32_bf16 v[12:15], v[32:35], v[56:59], v[12:15]
    v_mfma_f32_16x16x32_bf16 v[16:19], v[36:39], v[56:59], v[16:19]
L_pvdone:
    s_nop 7
    v_and_or_b32 v12, v12, s53, v152
    v_and_or_b32 v13, v13, s53, v153
    v_and_or_b32 v14, v14, s53, v154
    v_and_or_b32 v15, v15, s53, v155
    v_and_or_b32 v16, v16, s53, v152
    v_and_or_b32 v17, v17, s53, v153
    v_and_or_b32 v18, v18, s53, v154
    v_and_or_b32 v19, v19, s53, v155
    s_mov_b64 exec, s[50:51]
    s_cmp_eq_u32 s57, 0
    s_cbranch_scc0 L_opslow
    buffer_store_dwordx4 v[12:15], v109, s[32:35], s38 offen offset:1024
    buffer_store_dwordx4 v[16:19], v109, s[32:35], s38 offen offset:1280
L_opdone:
    s_mov_b64 exec, -1
L_wf23:
    ds_read_b32 v22, v6 offset:20
    s_waitcnt lgkmcnt(0)
    v_cmp_eq_u32 vcc, -1, v22
    s_cbranch_vccnz L_wf23
    ds_read_b64_tr_b16 v[60:61], v7 offset:40960
    ds_read_b64_tr_b16 v[62:63], v7 offset:41984
    ds_read_b64_tr_b16 v[64:65], v7 offset:45056
    ds_read_b64_tr_b16 v[66:67], v7 offset:46080
L_wf24:
    ds_read_b32 v22, v6 offset:32
    s_waitcnt lgkmcnt(0)
    v_cmp_eq_u32 vcc, -1, v22
    s_cbranch_vccnz L_wf24
    ds_read_b128 v[68:71], v117
    ds_read_b128 v[72:75], v117 offset:64
    s_waitcnt lgkmcnt(0)
    v_mfma_f32_16x16x32_bf16 v[8:11], v[60:63], v[68:71], 0
    v_mfma_f32_16x16x32_bf16 v[8:11], v[64:67], v[72:75], v[8:11]
L_wf25:
    ds_read_b32 v22, v6 offset:28
    s_waitcnt lgkmcnt(0)
    v_cmp_eq_u32 vcc, -1, v22
    s_cbranch_vccnz L_wf25
    v_readfirstlane_b32 s76, v22
    s_xor_b32 s76, s76, s28
    s_or_b32 s77, s76, s57
    s_cselect_b32 s77, 2, 1
    s_and_b32 s37, s29, 3
    s_or_b32 s76, s76, s37
    s_cselect_b32 s76, s77, 0
    s_waitcnt vmcnt(0)
    buffer_load_dwordx4 v[24:27], v113, s[32:35], s44 offen offset:1024 sc1
    buffer_load_dwordx4 v[28:31], v113, s[32:35], s45 offen offset:1024 sc1
    buffer_load_dwordx4 v[32:35], v113, s[32:35], s46 offen offset:1024 sc1
    buffer_load_dwordx4 v[36:39], v113, s[32:35], s47 offen offset:1024 sc1
L_wf26:
    ds_read_b32 v22, v6 offset:16
    s_waitcnt lgkmcnt(0)
    v_cmp_eq_u32 vcc, -1, v22
    s_cbranch_vccnz L_wf26
    ds_read_b64_tr_b16 v[60:61], v7 offset:16384
    ds_read_b64_tr_b16 v[62:63], v7 offset:17408
    ds_read_b64_tr_b16 v[64:65], v7 offset:20480
    ds_read_b64_tr_b16 v[66:67], v7 offset:21504
    ds_read_b64_tr_b16 v[68:69], v7 offset:24576
    ds_read_b64_tr_b16 v[70:71], v7 offset:25600
    ds_read_b64_tr_b16 v[72:73], v7 offset:28672
    ds_read_b64_tr_b16 v[74:75], v7 offset:29696
    s_branch L_ochk
L_og27:
    buffer_load_dwordx4 v[24:27], v113, s[32:35], s44 offen offset:1024 sc1
    buffer_load_dwordx4 v[28:31], v113, s[32:35], s45 offen offset:1024 sc1
    buffer_load_dwordx4 v[32:35], v113, s[32:35], s46 offen offset:1024 sc1
    buffer_load_dwordx4 v[36:39], v113, s[32:35], s47 offen offset:1024 sc1
L_ochk:
    ds_read_b128 v[40:43], v114
    s_waitcnt vmcnt(0)
    v_bitop3_b32 v88, v24, v28, s72 bitop3:0x7e
    v_bitop3_b32 v89, v25, v29, s73 bitop3:0x7e
    v_bitop3_b32 v90, v26, v30, s74 bitop3:0x7e
    v_bitop3_b32 v91, v27, v31, s75 bitop3:0x7e
    v_bitop3_b32 v92, v32, v36, s72 bitop3:0x7e
    v_bitop3_b32 v93, v33, v37, s73 bitop3:0x7e
    v_bitop3_b32 v94, v34, v38, s74 bitop3:0x7e
    v_bitop3_b32 v95, v35, v39, s75 bitop3:0x7e
    v_or3_b32 v88, v88, v89, v90
    v_or3_b32 v91, v91, v92, v93
    v_or3_b32 v94, v94, v95, v88
    v_or_b32 v91, v91, v94
    v_cmp_ne_u32_sdwa vcc, v91, v123 src0_sel:BYTE_0 src1_sel:DWORD
    s_cbranch_vccz L_ok28
    s_add_u32 s101, s101, 1
    s_cmp_lt_u32 s101, 262144
    s_cbranch_scc1 L_og27
L_ok28:
    s_waitcnt lgkmcnt(0)
    v_max3_u32 v22, v40, v41, v42
    v_max3_u32 v22, v22, v43, v43
    v_cmp_eq_u32 vcc, -1, v22
    s_cbranch_vccz L_alokA
L_al29:
    ds_read_b128 v[40:43], v114
    s_waitcnt lgkmcnt(0)
    v_max3_u32 v22, v40, v41, v42
    v_max3_u32 v22, v22, v43, v43
    v_cmp_eq_u32 vcc, -1, v22
    s_cbranch_vccnz L_al29
L_alokA:
    v_pk_mul_f32 v[12:13], v[24:25], v[40:41] op_sel_hi:[1,0]
    v_pk_mul_f32 v[14:15], v[26:27], v[40:41] op_sel_hi:[1,0]
    v_pk_fma_f32 v[12:13], v[28:29], v[40:41], v[12:13] op_sel:[0,1,0] op_sel_hi:[1,1,1]
    v_pk_fma_f32 v[14:15], v[30:31], v[40:41], v[14:15] op_sel:[0,1,0] op_sel_hi:[1,1,1]
    v_pk_fma_f32 v[12:13], v[32:33], v[42:43], v[12:13] op_sel_hi:[1,0,1]
    v_pk_fma_f32 v[14:15], v[34:35], v[42:43], v[14:15] op_sel_hi:[1,0,1]
    v_pk_fma_f32 v[12:13], v[36:37], v[42:43], v[12:13] op_sel:[0,1,0] op_sel_hi:[1,1,1]
    v_pk_fma_f32 v[14:15], v[38:39], v[42:43], v[14:15] op_sel:[0,1,0] op_sel_hi:[1,1,1]
    s_nop 1
    v_permlane16_swap_b32 v12, v14
    v_permlane16_swap_b32 v13, v15
    v_pk_add_f32 v[12:13], v[12:13], v[14:15]
    v_mov_b32 v14, v12
    v_mov_b32 v15, v13
    s_nop 0
    v_permlane32_swap_b32 v14, v12
    v_permlane32_swap_b32 v15, v13
    v_pk_add_f32 v[12:13], v[12:13], v[14:15]
    v_cvt_pk_bf16_f32 v12, v12, v13
    v_min_u32 v12, s52, v12
    ds_write_b32 v115, v12
L_ol30:
    ds_read_b128 v[76:79], v116 offset:0
    ds_read_b128 v[80:83], v116 offset:64
    ds_read_b128 v[84:87], v116 offset:128
    ds_read_b128 v[88:91], v116 offset:192
    s_waitcnt lgkmcnt(0)
    v_max3_u32 v22, v76, v77, v78
    v_max3_u32 v22, v22, v79, v80
    v_max3_u32 v22, v22, v81, v82
    v_max3_u32 v22, v22, v83, v84
    v_max3_u32 v22, v22, v85, v86
    v_max3_u32 v22, v22, v87, v88
    v_max3_u32 v22, v22, v89, v90
    v_max3_u32 v22, v22, v91, v91
    v_cmp_eq_u32 vcc, -1, v22
    s_cbranch_vccnz L_ol30
    v_mfma_f32_16x16x32_bf16 v[8:11], v[60:63], v[76:79], v[8:11]
    v_mfma_f32_16x16x32_bf16 v[8:11], v[64:67], v[80:83], v[8:11]
    v_mfma_f32_16x16x32_bf16 v[8:11], v[68:71], v[84:87], v[8:11]
    v_mfma_f32_16x16x32_bf16 v[8:11], v[72:75], v[88:91], v[8:11]
    s_cmp_lt_u32 s76, 2
    s_nop 6
    v_and_or_b32 v8, v8, s53, v152
    v_and_or_b32 v9, v9, s53, v153
    v_and_or_b32 v10, v10, s53, v154
    v_and_or_b32 v11, v11, s53, v155
    s_mov_b64 exec, s[48:49]
    s_cbranch_scc1 L_final
    buffer_store_dwordx4 v[8:11], v118, s[32:35], s68 offen sc1
    s_endpgm
L_opslow:
    buffer_store_dwordx4 v[12:15], v109, s[32:35], s38 offen offset:1024 sc1
    buffer_store_dwordx4 v[16:19], v109, s[32:35], s38 offen offset:1280 sc1
    s_branch L_opdone
L_final:
    buffer_store_dwordx4 v[8:11], v118, s[32:35], s68 offen
    s_mov_b64 exec, -1
    s_cmp_eq_u32 s76, 0
    s_cbranch_scc0 L_end
    buffer_load_dwordx4 v[24:27], v99, s[32:35], s70 offen offset:0 sc1
    buffer_load_dwordx4 v[28:31], v99, s[32:35], s70 offen offset:512 sc1
    buffer_load_dwordx4 v[32:35], v99, s[32:35], s70 offen offset:1024 sc1
    buffer_load_dwordx4 v[36:39], v99, s[32:35], s70 offen offset:1536 sc1
L_fp:
    s_waitcnt vmcnt(0)
    v_bitop3_b32 v76, v24, v28, s72 bitop3:0x7e
    v_bitop3_b32 v77, v25, v29, s73 bitop3:0x7e
    v_bitop3_b32 v78, v26, v30, s74 bitop3:0x7e
    v_bitop3_b32 v79, v27, v31, s75 bitop3:0x7e
    v_bitop3_b32 v80, v32, v36, s72 bitop3:0x7e
    v_bitop3_b32 v81, v33, v37, s73 bitop3:0x7e
    v_bitop3_b32 v82, v34, v38, s74 bitop3:0x7e
    v_bitop3_b32 v83, v35, v39, s75 bitop3:0x7e
    v_or3_b32 v76, v76, v77, v78
    v_or3_b32 v79, v79, v80, v81
    v_or3_b32 v82, v82, v83, v76
    v_or_b32 v79, v79, v82
    v_cmp_ne_u32_sdwa vcc, v79, v123 src0_sel:BYTE_0 src1_sel:DWORD
    s_cbranch_vccz L_fpok0
    buffer_load_dwordx4 v[24:27], v99, s[32:35], s70 offen offset:0 sc1
    buffer_load_dwordx4 v[28:31], v99, s[32:35], s70 offen offset:512 sc1
    buffer_load_dwordx4 v[32:35], v99, s[32:35], s70 offen offset:1024 sc1
    buffer_load_dwordx4 v[36:39], v99, s[32:35], s70 offen offset:1536 sc1
    s_add_u32 s101, s101, 1
    s_cmp_lt_u32 s101, 262144
    s_cbranch_scc1 L_fp
L_fpok0:
    v_pk_add_f32 v[12:13], v[24:25], v[28:29]
    v_pk_add_f32 v[14:15], v[26:27], v[30:31]
    v_pk_add_f32 v[16:17], v[32:33], v[36:37]
    v_pk_add_f32 v[18:19], v[34:35], v[38:39]
L_fpj:
    v_pk_add_f32 v[12:13], v[12:13], v[16:17]
    v_pk_add_f32 v[14:15], v[14:15], v[18:19]
    s_nop 1
    v_permlane32_swap_b32 v12, v14
    v_permlane32_swap_b32 v13, v15
    v_pk_add_f32 v[12:13], v[12:13], v[14:15]
    v_mov_b32 v14, v12
    v_mov_b32 v15, v13
    s_nop 0
    v_permlane16_swap_b32 v14, v12
    v_permlane16_swap_b32 v15, v13
    v_pk_add_f32 v[12:13], v[12:13], v[14:15]
    v_lshlrev_b32 v14, 16, v97
    v_and_b32 v15, s36, v97
    v_add_f32 v12, v12, v12 row_ror:8
    v_add_f32 v13, v13, v13 row_ror:8
    v_pk_add_f32 v[12:13], v[12:13], v[14:15]
    v_cvt_pk_bf16_f32 v12, v12, v13
    s_mov_b32 s40, 0xff
    s_mov_b32 s41, 0xff
    s_mov_b64 exec, s[40:41]
    global_store_dword v98, v12, s[22:23]
    s_or_b32 s37, s29, s30
    s_cbranch_scc1 L_cend
    v_mov_b32 v20, s54
    s_mov_b64 exec, 1
    global_store_dword v123, v20, s[26:27]
L_cend:
L_end:
    s_endpgm
.section .rodata,"a"
.p2align 6
.amdhsa_kernel parallel_sum__sliding_block_cached__dense_activation_mish__decode_kernel
.amdhsa_next_free_vgpr 160
.amdhsa_next_free_sgpr 102
.amdhsa_accum_offset 160
.amdhsa_group_segment_fixed_size 0
.amdhsa_kernarg_size 96
.amdhsa_user_sgpr_count 2
.amdhsa_user_sgpr_kernarg_segment_ptr 1
.amdhsa_system_sgpr_workgroup_id_x 1
.amdhsa_float_denorm_mode_32 3
.end_amdhsa_kernel
```
